```python
import torch

def _softmax(x, axis=-1):
    return torch.softmax(x, dim=axis)

def _gelu(x):
    return torch.nn.functional.gelu(x, approximate='tanh')

def _silu(x):
    return torch.nn.functional.silu(x)

def _sigmoid(x):
    return torch.sigmoid(x)

def _layernorm(x, axis=-1, eps=1e-05):
    m = x.mean(dim=axis, keepdim=True)
    v = x.var(dim=axis, keepdim=True, unbiased=False)
    return (x - m) / torch.sqrt(v + eps)

def _scatter_add(tgt, idx, src, axis=0):
    return tgt.clone().index_add_(axis, idx, src)

def _segment_sum(src, seg, n):
    out = torch.zeros((n,) + src.shape[1:], dtype=src.dtype)
    return out.index_add_(0, seg, src)

def _pad(x, pw):
    flat = tuple((v for pair in reversed(pw) for v in pair))
    return torch.nn.functional.pad(x, flat)
kernel_name = 'adaLN_cond__gqa_block_cached__geglu_ffn__decode'

def setup_inputs():

    _w = lambda a: (lambda t: t.to(torch.bfloat16) if t.is_floating_point() else t)(torch.as_tensor(a))

    def _A_setup():
        B, Sq, D = (4, 1, 448)
        Hq, Hkv, Sk, Dh = (16, 8, 4096, 256)
        assert Hq % Hkv == 0, (Hq, Hkv)
        return {'x': _w((lambda *s: torch.randn(*s, dtype=torch.bfloat16) * 0.05)(B, Sq, D)), 'k_cache': _w((lambda *s: torch.randn(*s, dtype=torch.bfloat16) * 3.2)(B, Hkv, Sk, Dh)), 'v_cache': _w((lambda *s: torch.randn(*s, dtype=torch.bfloat16) * 0.4)(B, Hkv, Sk, Dh)), 'wq': _w((lambda *s: torch.randn(*s, dtype=torch.bfloat16) * 3.2)(D, Hq * Dh) * D ** (-0.5)), 'wo': _w((lambda *s: torch.randn(*s, dtype=torch.bfloat16) * 0.4)(Hq * Dh, D) * (Hq * Dh) ** (-0.5))}
    _A_in = _A_setup()

    def _B_setup():
        B, S, D, F = (4, 1, 448, 1792)
        return {'x': _w((lambda *s: torch.randn(*s, dtype=torch.bfloat16) * 0.05)(B, S, D)), 'w_gate': _w((lambda *s: torch.randn(*s, dtype=torch.bfloat16) * 0.05)(D, F)), 'w_up': _w((lambda *s: torch.randn(*s, dtype=torch.bfloat16) * 0.05)(D, F)), 'w_down': _w((lambda *s: torch.randn(*s, dtype=torch.bfloat16) * 0.05)(F, D))}
    _B_in = _B_setup()
    return {'A_x': _A_in['x'], 'A_k_cache': _A_in['k_cache'], 'A_v_cache': _A_in['v_cache'], 'A_wq': _A_in['wq'], 'A_wo': _A_in['wo'], 'B_x': _B_in['x'], 'B_w_gate': _B_in['w_gate'], 'B_w_up': _B_in['w_up'], 'B_w_down': _B_in['w_down'], 'c': _w((lambda *s: torch.randn(*s, dtype=torch.bfloat16) * 0.2)(4, 448) * 8.0), 'w_mod': _w((lambda *s: torch.randn(*s, dtype=torch.bfloat16) * 0.2)(448, 6 * 448) * 448 ** (-0.5) * 8.0)}

def reference(A_x, A_k_cache, A_v_cache, A_wq, A_wo, B_x, B_w_gate, B_w_up, B_w_down, c, w_mod):

    def _A_ref(x, k_cache, v_cache, wq, wo):
        B, Sq, D = x.shape
        Hq, Dh = (16, 256)
        Hkv = k_cache.shape[1]
        rep = Hq // Hkv
        q = (lambda x, *d: x.permute(*d))((x @ wq).reshape(B, Sq, Hq, Dh), 0, 2, 1, 3)
        k = (lambda x, n, axis: torch.repeat_interleave(x, n, dim=axis))(k_cache, rep, axis=1)
        v = (lambda x, n, axis: torch.repeat_interleave(x, n, dim=axis))(v_cache, rep, axis=1)
        scores = torch.einsum('bhqd,bhkd->bhqk', q, k) * Dh ** (-0.5)
        p = _softmax(scores, axis=-1)
        o = torch.einsum('bhqk,bhkd->bhqd', p, v)
        return (lambda x, *d: x.permute(*d))(o, 0, 2, 1, 3).reshape(B, Sq, Hq * Dh) @ wo

    def _B_ref(x, w_gate, w_up, w_down):
        return _gelu(x @ w_gate) * (x @ w_up) @ w_down
    x = A_x
    mod = (_silu(c) @ w_mod).reshape(c.shape[0], 6, 1, -1)
    sa, ca, ga, sb, cb, gb = (mod[:, 0].clone(), mod[:, 1].clone(), mod[:, 2].clone(), mod[:, 3].clone(), mod[:, 4].clone(), mod[:, 5].clone())
    h = _layernorm(x, axis=-1) * (1 + ca) + sa
    x = x + ga * _A_ref(h, A_k_cache, A_v_cache, A_wq, A_wo)
    h = _layernorm(x, axis=-1) * (1 + cb) + sb
    x = x + gb * _B_ref(h, B_w_gate, B_w_up, B_w_down)
    return x
```

```asm
; @launch grid=(256,1,1) block=(512,1,1) lds=124992
.amdgcn_target "amdgcn-amd-amdhsa--gfx950"
.text
.globl adaLN_cond__gqa_block_cached__geglu_ffn__decode_kernel
.p2align 8
.type adaLN_cond__gqa_block_cached__geglu_ffn__decode_kernel,@function
adaLN_cond__gqa_block_cached__geglu_ffn__decode_kernel:
    s_cmp_ge_u32 s2, 256
    s_cbranch_scc1 L_end
    s_load_dwordx16 s[64:79], s[0:1], 0
    s_load_dwordx8 s[80:87], s[0:1], 64
    s_load_dwordx2 s[90:91], s[0:1], 104
    s_getpc_b64 s[88:89]
L_pc:
    v_lshlrev_b32 v9, 6, v0
    v_min_u32 v9, L_end - L_pc - 4, v9
    global_load_dword v15, v9, s[88:89]
    s_setprio 3
    v_lshrrev_b32 v1, 6, v0
    s_sub_u32 s24, s2, 1
    v_readfirstlane_b32 s3, v1
    v_and_b32 v1, 63, v0
    v_and_b32 v2, 15, v0
    v_lshrrev_b32 v3, 4, v1
    v_lshrrev_b32 v4, 2, v2
    v_lshlrev_b32 v4, 11, v4
    v_lshl_add_u32 v4, v3, 6, v4
    v_and_b32 v12, 3, v0
    v_lshl_add_u32 v4, v12, 4, v4
    v_lshlrev_b32 v6, 4, v1
    v_mov_b32 v8, 0
    v_lshlrev_b32 v9, 2, v1
    v_add_u32 v9, 124736, v9
    ds_write_b32 v9, v8
    s_and_b32 s24, s24, 7
    s_lshr_b32 s27, s2, 3
    s_and_b32 s25, s27, 3
    s_lshr_b32 s26, s27, 2
    s_lshl_b32 s63, s25, 3
    s_add_u32 s63, s63, s26
    s_lshl_b32 s33, s63, 21
    s_and_b32 s34, s3, 3
    s_lshl_b32 s35, s24, 2
    s_add_u32 s34, s34, s35
    s_lshr_b32 s35, s3, 2
    s_mul_i32 s35, s35, 28
    s_add_u32 s34, s34, s35
    s_lshl_b32 s34, s34, 14
    s_add_u32 s30, s33, s34
    s_mul_i32 s34, s24, 5
    s_add_u32 s34, s34, s27
    s_and_b32 s34, s34, 31
    s_mul_i32 s34, s34, 7
    s_add_u32 s34, s34, s24
    s_cmp_eq_u32 s24, 7
    s_cselect_b32 s27, s27, s34
    s_mov_b32 s6, 67108864
    s_mov_b32 s7, 0x20000
    s_cmp_lt_u32 s27, 42
    s_waitcnt lgkmcnt(0)
    s_barrier
    global_load_dword v8, v8, s[90:91] sc1
    s_mov_b32 s4, s66
    s_mov_b32 s5, s67
    s_cbranch_scc1 L_early
    buffer_load_dwordx4 v[128:131], v4, s[4:7], s30 offen offset:0 nt
    buffer_load_dwordx4 v[132:135], v4, s[4:7], s30 offen offset:256 nt
    buffer_load_dwordx4 v[136:139], v4, s[4:7], s30 offen offset:512 nt
    buffer_load_dwordx4 v[140:143], v4, s[4:7], s30 offen offset:768 nt
    buffer_load_dwordx4 v[144:147], v4, s[4:7], s30 offen offset:1024 nt
    buffer_load_dwordx4 v[148:151], v4, s[4:7], s30 offen offset:1280 nt
    buffer_load_dwordx4 v[152:155], v4, s[4:7], s30 offen offset:1536 nt
    buffer_load_dwordx4 v[156:159], v4, s[4:7], s30 offen offset:1792 nt
    s_branch L_main0
L_early:
    s_cmp_eq_u32 s24, 7
    s_cselect_b32 s20, s64, s82
    s_cselect_b32 s21, s65, s83
    s_mov_b32 s22, 3584
    s_mov_b32 s23, 0x20000
    s_cselect_b32 s16, s70, s84
    s_cselect_b32 s17, s71, s85
    s_mov_b32 s55, 5376
    s_cselect_b32 s55, 8192, s55
    s_mov_b32 s33, 1024
    s_cselect_b32 s33, 896, s33
    s_cselect_b32 s34, 3, 4
    s_cselect_b32 s35, 6, 0
    s_cselect_b32 s36, 48, 64
    s_cselect_b32 s56, 8, 7
    s_mul_i32 s33, s33, s3
    s_lshl_b32 s35, 8, s35
    v_lshlrev_b32 v13, s34, v1
    v_cmp_gt_u32 vcc, s36, v1
    buffer_load_dwordx2 v[16:17], v13, s[20:23], s33 offen
    v_add_u32 v13, s35, v13
    v_mov_b32 v9, 0x100000
    v_cndmask_b32 v13, v9, v13, vcc
    buffer_load_dwordx2 v[18:19], v13, s[20:23], s33 offen
    s_mul_i32 s18, s55, 448
    s_mov_b32 s19, 0x20000
    v_lshrrev_b32 v10, 3, v1
    v_and_b32 v11, 7, v1
    v_and_b32 v9, 2, v10
    v_xor_b32 v11, v11, v9
    v_lshlrev_b32 v11, 4, v11
    s_and_b32 s34, s3, 1
    s_lshl_b32 s34, s34, 6
    v_xor_b32 v11, s34, v11
    v_mad_u32_u24 v7, v10, s55, v11
    s_lshl_b32 s54, s27, s56
    s_lshl_b32 s55, s55, 3
    s_mul_i32 s33, s3, 7
    s_mul_i32 s34, s33, s55
    s_add_u32 s54, s54, s34
    s_lshl_b32 s56, s33, 10
    s_mov_b32 m0, s56
    s_add_u32 s56, s56, 1024
    buffer_load_dwordx4 v7, s[16:19], s54 offen nt lds
    s_add_u32 s54, s54, s55
    v_xor_b32 v7, 64, v7
    s_mov_b32 m0, s56
    s_add_u32 s56, s56, 1024
    buffer_load_dwordx4 v7, s[16:19], s54 offen nt lds
    s_add_u32 s54, s54, s55
    v_xor_b32 v7, 64, v7
    s_mov_b32 m0, s56
    s_add_u32 s56, s56, 1024
    buffer_load_dwordx4 v7, s[16:19], s54 offen nt lds
    s_add_u32 s54, s54, s55
    v_xor_b32 v7, 64, v7
    s_mov_b32 m0, s56
    s_add_u32 s56, s56, 1024
    buffer_load_dwordx4 v7, s[16:19], s54 offen nt lds
    s_add_u32 s54, s54, s55
    v_xor_b32 v7, 64, v7
    s_mov_b32 m0, s56
    s_add_u32 s56, s56, 1024
    buffer_load_dwordx4 v7, s[16:19], s54 offen nt lds
    s_add_u32 s54, s54, s55
    v_xor_b32 v7, 64, v7
    s_mov_b32 m0, s56
    s_add_u32 s56, s56, 1024
    buffer_load_dwordx4 v7, s[16:19], s54 offen nt lds
    s_add_u32 s54, s54, s55
    v_xor_b32 v7, 64, v7
    s_mov_b32 m0, s56
    s_add_u32 s56, s56, 1024
    buffer_load_dwordx4 v7, s[16:19], s54 offen nt lds
    s_add_u32 s54, s54, s55
    v_xor_b32 v7, 64, v7
    s_cmp_eq_u32 s24, 7
    s_cbranch_scc1 L_svc
    s_mov_b32 s12, s90
    s_mov_b32 s13, s91
    s_mov_b32 s14, 8388608
    s_mov_b32 s15, 0x20000
    s_mov_b32 s44, -1
    s_mov_b32 s45, 0x0000ffff
    s_mov_b32 s60, 0xffff0000
    s_mov_b32 s29, 0x80000
    s_mov_b32 s38, 0xffff0000
    s_mov_b32 s39, 0
    s_mov_b32 s40, 0
    s_mov_b32 s41, 0xffff
    s_mov_b32 s42, 0
    s_mov_b32 s43, 0xffff0000
    s_mov_b32 s46, 0x22222222
    s_mov_b32 s47, 0x22222222
    s_mov_b32 s48, 0x44444444
    s_mov_b32 s49, 0x44444444
    s_mov_b32 s50, 0x88888888
    s_mov_b32 s51, 0x88888888
    s_cmp_lt_u32 s3, 4
    s_cbranch_scc1 L_m0
    buffer_load_dwordx4 v[128:131], v4, s[4:7], s30 offen offset:0 nt
    buffer_load_dwordx4 v[132:135], v4, s[4:7], s30 offen offset:256 nt
    buffer_load_dwordx4 v[136:139], v4, s[4:7], s30 offen offset:512 nt
    buffer_load_dwordx4 v[140:143], v4, s[4:7], s30 offen offset:768 nt
    buffer_load_dwordx4 v[144:147], v4, s[4:7], s30 offen offset:1024 nt
    buffer_load_dwordx4 v[148:151], v4, s[4:7], s30 offen offset:1280 nt
    buffer_load_dwordx4 v[152:155], v4, s[4:7], s30 offen offset:1536 nt
    buffer_load_dwordx4 v[156:159], v4, s[4:7], s30 offen offset:1792 nt
    s_waitcnt vmcnt(8)
    s_barrier
    s_branch L_main1
L_m0:
    s_waitcnt vmcnt(7)
    v_readfirstlane_b32 s28, v8
    s_add_u32 s28, s28, 0x9e3779b9
    v_lshlrev_b32 v24, 16, v16
    v_and_b32 v25, s60, v16
    v_lshlrev_b32 v26, 16, v17
    v_and_b32 v27, s60, v17
    v_lshlrev_b32 v28, 16, v18
    v_and_b32 v29, s60, v18
    v_lshlrev_b32 v30, 16, v19
    v_and_b32 v31, s60, v19
    s_lshl_b32 s35, s3, 10
    s_add_u32 s35, s35, 114752
    v_add_u32 v9, s35, v6
    v_mul_f32 v32, 0xbfb8aa3b, v24
    v_mul_f32 v33, 0xbfb8aa3b, v25
    v_mul_f32 v34, 0xbfb8aa3b, v26
    v_mul_f32 v35, 0xbfb8aa3b, v27
    v_mul_f32 v36, 0xbfb8aa3b, v28
    v_mul_f32 v37, 0xbfb8aa3b, v29
    v_mul_f32 v38, 0xbfb8aa3b, v30
    v_mul_f32 v39, 0xbfb8aa3b, v31
    v_exp_f32 v32, v32
    v_exp_f32 v33, v33
    v_exp_f32 v34, v34
    v_exp_f32 v35, v35
    v_exp_f32 v36, v36
    v_exp_f32 v37, v37
    v_exp_f32 v38, v38
    v_exp_f32 v39, v39
    v_add_f32 v32, 1.0, v32
    v_add_f32 v33, 1.0, v33
    v_add_f32 v34, 1.0, v34
    v_add_f32 v35, 1.0, v35
    v_add_f32 v36, 1.0, v36
    v_add_f32 v37, 1.0, v37
    v_add_f32 v38, 1.0, v38
    v_add_f32 v39, 1.0, v39
    v_rcp_f32 v32, v32
    v_rcp_f32 v33, v33
    v_rcp_f32 v34, v34
    v_rcp_f32 v35, v35
    v_rcp_f32 v36, v36
    v_rcp_f32 v37, v37
    v_rcp_f32 v38, v38
    v_rcp_f32 v39, v39
    v_mul_f32 v24, v24, v32
    v_mul_f32 v25, v25, v33
    v_mul_f32 v26, v26, v34
    v_mul_f32 v27, v27, v35
    v_mul_f32 v28, v28, v36
    v_mul_f32 v29, v29, v37
    v_mul_f32 v30, v30, v38
    v_mul_f32 v31, v31, v39
    v_cvt_pk_bf16_f32 v24, v24, v25
    v_cvt_pk_bf16_f32 v25, v26, v27
    v_cvt_pk_bf16_f32 v26, v28, v29
    v_cvt_pk_bf16_f32 v27, v30, v31
    ds_write_b128 v9, v[24:27]
    v_lshrrev_b32 v13, 2, v2
    v_lshl_add_u32 v13, v3, 3, v13
    v_lshlrev_b32 v13, 7, v13
    v_lshl_add_u32 v13, v12, 3, v13
    v_bfe_u32 v9, v1, 3, 2
    v_xor_b32 v9, s3, v9
    v_lshl_add_u32 v13, v9, 5, v13
    s_lshl_b32 s36, s27, 8
    s_lshl_b32 s33, s3, 6
    s_add_u32 s36, s36, s33
    s_add_u32 s36, s36, 24576
L_m1:
    s_waitcnt vmcnt(0) lgkmcnt(0)
    s_barrier
    s_cmp_lt_u32 s3, 4
    s_cbranch_scc0 L_m2
    ds_read_b64_tr_b16 v[64:65], v13 offset:0
    ds_read_b64_tr_b16 v[66:67], v13 offset:512
    ds_read_b64_tr_b16 v[68:69], v13 offset:4096
    ds_read_b64_tr_b16 v[70:71], v13 offset:4608
    ds_read_b64_tr_b16 v[72:73], v13 offset:8192
    ds_read_b64_tr_b16 v[74:75], v13 offset:8704
    ds_read_b64_tr_b16 v[76:77], v13 offset:12288
    ds_read_b64_tr_b16 v[78:79], v13 offset:12800
    s_waitcnt lgkmcnt(6)
    ds_read_b64_tr_b16 v[80:81], v13 offset:16384
    ds_read_b64_tr_b16 v[82:83], v13 offset:16896
    ds_read_b64_tr_b16 v[84:85], v13 offset:20480
    ds_read_b64_tr_b16 v[86:87], v13 offset:20992
    ds_read_b64_tr_b16 v[88:89], v13 offset:24576
    ds_read_b64_tr_b16 v[90:91], v13 offset:25088
    ds_read_b64_tr_b16 v[92:93], v13 offset:28672
    ds_read_b64_tr_b16 v[94:95], v13 offset:29184
    s_waitcnt lgkmcnt(6)
    ds_read_b64_tr_b16 v[96:97], v13 offset:32768
    ds_read_b64_tr_b16 v[98:99], v13 offset:33280
    ds_read_b64_tr_b16 v[100:101], v13 offset:36864
    ds_read_b64_tr_b16 v[102:103], v13 offset:37376
    ds_read_b64_tr_b16 v[104:105], v13 offset:40960
    ds_read_b64_tr_b16 v[106:107], v13 offset:41472
    ds_read_b64_tr_b16 v[108:109], v13 offset:45056
    ds_read_b64_tr_b16 v[110:111], v13 offset:45568
    s_waitcnt lgkmcnt(6)
    ds_read_b64_tr_b16 v[112:113], v13 offset:49152
    ds_read_b64_tr_b16 v[114:115], v13 offset:49664
    ds_read_b64_tr_b16 v[116:117], v13 offset:53248
    ds_read_b64_tr_b16 v[118:119], v13 offset:53760
    v_mul_u32_u24 v9, 896, v12
    v_lshl_add_u32 v9, v3, 4, v9
    v_add_u32 v9, 114752, v9
    s_waitcnt lgkmcnt(0)
    ds_read_b128 v[128:131], v9 offset:0
    ds_read_b128 v[132:135], v9 offset:64
    ds_read_b128 v[136:139], v9 offset:128
    ds_read_b128 v[140:143], v9 offset:192
    ds_read_b128 v[144:147], v9 offset:256
    ds_read_b128 v[148:151], v9 offset:320
    ds_read_b128 v[152:155], v9 offset:384
    ds_read_b128 v[156:159], v9 offset:448
    ds_read_b128 v[160:163], v9 offset:512
    ds_read_b128 v[164:167], v9 offset:576
    ds_read_b128 v[168:171], v9 offset:640
    ds_read_b128 v[172:175], v9 offset:704
    ds_read_b128 v[176:179], v9 offset:768
    ds_read_b128 v[180:183], v9 offset:832
    s_waitcnt lgkmcnt(13)
    v_mfma_f32_16x16x32_bf16 v[16:19], v[64:67], v[128:131], 0
    s_waitcnt lgkmcnt(12)
    v_mfma_f32_16x16x32_bf16 v[16:19], v[68:71], v[132:135], v[16:19]
    s_waitcnt lgkmcnt(11)
    v_mfma_f32_16x16x32_bf16 v[16:19], v[72:75], v[136:139], v[16:19]
    s_waitcnt lgkmcnt(10)
    v_mfma_f32_16x16x32_bf16 v[16:19], v[76:79], v[140:143], v[16:19]
    s_waitcnt lgkmcnt(9)
    v_mfma_f32_16x16x32_bf16 v[16:19], v[80:83], v[144:147], v[16:19]
    s_waitcnt lgkmcnt(8)
    v_mfma_f32_16x16x32_bf16 v[16:19], v[84:87], v[148:151], v[16:19]
    s_waitcnt lgkmcnt(7)
    v_mfma_f32_16x16x32_bf16 v[16:19], v[88:91], v[152:155], v[16:19]
    s_waitcnt lgkmcnt(6)
    v_mfma_f32_16x16x32_bf16 v[16:19], v[92:95], v[156:159], v[16:19]
    s_waitcnt lgkmcnt(5)
    v_mfma_f32_16x16x32_bf16 v[16:19], v[96:99], v[160:163], v[16:19]
    s_waitcnt lgkmcnt(4)
    v_mfma_f32_16x16x32_bf16 v[16:19], v[100:103], v[164:167], v[16:19]
    s_waitcnt lgkmcnt(3)
    v_mfma_f32_16x16x32_bf16 v[16:19], v[104:107], v[168:171], v[16:19]
    s_waitcnt lgkmcnt(2)
    v_mfma_f32_16x16x32_bf16 v[16:19], v[108:111], v[172:175], v[16:19]
    s_waitcnt lgkmcnt(1)
    v_mfma_f32_16x16x32_bf16 v[16:19], v[112:115], v[176:179], v[16:19]
    s_waitcnt lgkmcnt(0)
    v_mfma_f32_16x16x32_bf16 v[16:19], v[116:119], v[180:183], v[16:19]
    v_mul_u32_u24 v9, 10752, v12
    v_lshl_add_u32 v9, v3, 4, v9
    v_mov_b32 v22, 0
    v_mov_b32 v23, s28
    s_mov_b32 exec_lo, 0x000f000f
    s_mov_b32 exec_hi, 0x000f000f
    s_nop 1
    v_cvt_pk_bf16_f32 v20, v16, v17
    v_cvt_pk_bf16_f32 v21, v18, v19
    buffer_store_dwordx4 v[20:23], v9, s[12:15], s36 offen sc1
    s_mov_b64 exec, -1
L_m2:
    buffer_load_dwordx4 v[128:131], v4, s[4:7], s30 offen offset:0 nt
    buffer_load_dwordx4 v[132:135], v4, s[4:7], s30 offen offset:256 nt
    buffer_load_dwordx4 v[136:139], v4, s[4:7], s30 offen offset:512 nt
    buffer_load_dwordx4 v[140:143], v4, s[4:7], s30 offen offset:768 nt
    buffer_load_dwordx4 v[144:147], v4, s[4:7], s30 offen offset:1024 nt
    buffer_load_dwordx4 v[148:151], v4, s[4:7], s30 offen offset:1280 nt
    buffer_load_dwordx4 v[152:155], v4, s[4:7], s30 offen offset:1536 nt
    buffer_load_dwordx4 v[156:159], v4, s[4:7], s30 offen offset:1792 nt
    s_branch L_main1
L_main0:
    s_mov_b32 s12, s90
    s_mov_b32 s13, s91
    s_mov_b32 s14, 8388608
    s_mov_b32 s15, 0x20000
    s_mov_b32 s44, -1
    s_mov_b32 s45, 0x0000ffff
    s_mov_b32 s60, 0xffff0000
    s_mov_b32 s29, 0x80000
    s_mov_b32 s38, 0xffff0000
    s_mov_b32 s39, 0
    s_mov_b32 s40, 0
    s_mov_b32 s41, 0xffff
    s_mov_b32 s42, 0
    s_mov_b32 s43, 0xffff0000
    s_mov_b32 s46, 0x22222222
    s_mov_b32 s47, 0x22222222
    s_mov_b32 s48, 0x44444444
    s_mov_b32 s49, 0x44444444
    s_mov_b32 s50, 0x88888888
    s_mov_b32 s51, 0x88888888
L_main1:
    s_mov_b32 s8, s68
    s_mov_b32 s9, s69
    s_mov_b32 s10, 67108864
    s_mov_b32 s11, 0x20000
    v_lshlrev_b32 v13, 12, v3
    v_lshl_add_u32 v13, v2, 4, v13
    v_lshrrev_b32 v5, 2, v2
    v_mul_u32_u24 v5, 2048, v5
    v_and_b32 v9, 255, v4
    v_add_u32 v5, v5, v9
    v_mul_u32_u24 v0, 2048, v3
    v_lshl_add_u32 v0, v2, 4, v0
    s_mov_b32 s52, 0xff00ff00
    s_mov_b32 s53, 0xff00ff00
    s_mov_b32 s57, 0x05040100
    s_mov_b32 s58, 0x07060302
    s_mov_b32 s59, 0x3db8aa3b
    s_add_u32 s33, s30, 8192
    buffer_load_dwordx4 v[160:163], v4, s[4:7], s33 offen offset:0 nt
    buffer_load_dwordx4 v[164:167], v4, s[4:7], s33 offen offset:256 nt
    buffer_load_dwordx4 v[168:171], v4, s[4:7], s33 offen offset:512 nt
    buffer_load_dwordx4 v[172:175], v4, s[4:7], s33 offen offset:768 nt
    buffer_load_dwordx4 v[176:179], v4, s[4:7], s33 offen offset:1024 nt
    buffer_load_dwordx4 v[180:183], v4, s[4:7], s33 offen offset:1280 nt
    s_waitcnt vmcnt(15)
    buffer_load_dwordx4 v[184:187], v4, s[4:7], s33 offen offset:1536 nt
    s_waitcnt vmcnt(15)
    buffer_load_dwordx4 v[188:191], v4, s[4:7], s33 offen offset:1792 nt
    s_setprio 2
    s_waitcnt vmcnt(15)
    buffer_load_dwordx4 v[64:67], v13, s[8:11], s30 offen offset:0 nt
    s_waitcnt vmcnt(15)
    buffer_load_dwordx4 v[96:99], v13, s[8:11], s30 offen offset:256 nt
    s_waitcnt vmcnt(15)
    buffer_load_dwordx4 v[68:71], v13, s[8:11], s30 offen offset:512 nt
    s_waitcnt vmcnt(15)
    buffer_load_dwordx4 v[100:103], v13, s[8:11], s30 offen offset:768 nt
    s_waitcnt vmcnt(15)
    buffer_load_dwordx4 v[72:75], v13, s[8:11], s30 offen offset:1024 nt
    s_waitcnt vmcnt(15)
    buffer_load_dwordx4 v[104:107], v13, s[8:11], s30 offen offset:1280 nt
    s_waitcnt vmcnt(15)
    buffer_load_dwordx4 v[76:79], v13, s[8:11], s30 offen offset:1536 nt
    s_waitcnt vmcnt(15)
    buffer_load_dwordx4 v[108:111], v13, s[8:11], s30 offen offset:1792 nt
    s_waitcnt vmcnt(15)
    buffer_load_dwordx4 v[80:83], v13, s[8:11], s30 offen offset:2048 nt
    s_waitcnt vmcnt(15)
    buffer_load_dwordx4 v[112:115], v13, s[8:11], s30 offen offset:2304 nt
    s_waitcnt vmcnt(15)
    buffer_load_dwordx4 v[84:87], v13, s[8:11], s30 offen offset:2560 nt
    s_waitcnt vmcnt(15)
    buffer_load_dwordx4 v[116:119], v13, s[8:11], s30 offen offset:2816 nt
    s_waitcnt vmcnt(15)
    buffer_load_dwordx4 v[88:91], v13, s[8:11], s30 offen offset:3072 nt
    s_waitcnt vmcnt(15)
    buffer_load_dwordx4 v[120:123], v13, s[8:11], s30 offen offset:3328 nt
    s_waitcnt vmcnt(15)
    buffer_load_dwordx4 v[92:95], v13, s[8:11], s30 offen offset:3584 nt
    s_waitcnt vmcnt(15)
    buffer_load_dwordx4 v[124:127], v13, s[8:11], s30 offen offset:3840 nt
L_sdone:
    v_readfirstlane_b32 s28, v8
    s_add_u32 s28, s28, 0x9e3779b9
    s_lshl_b32 s33, s63, 8
    s_add_u32 s33, s33, 8192
    s_add_u32 s84, s90, s33
    s_addc_u32 s85, s91, 0
    s_lshl_b32 s30, s63, 21
    s_add_u32 s30, s30, 917504
    s_cmp_lt_u32 s3, 4
    s_mov_b32 s55, 32
    s_cselect_b32 s55, 144, s55
L_peek:
    s_mov_b64 s[70:71], 0
    s_atomic_add_x2 s[70:71], s[84:85], 0 glc
    s_waitcnt lgkmcnt(0)
    s_cmp_eq_u32 s71, s28
    s_cbranch_scc1 L_peek_ok
    s_mov_b32 s68, 0
    s_mov_b32 s69, s28
    s_atomic_cmpswap_x2 s[68:71], s[84:85], 0 glc
    s_waitcnt lgkmcnt(0)
    s_sub_u32 s29, s29, 1
    s_cbranch_scc0 L_peek
    s_mov_b32 s29, 0
L_peek_ok:
    s_mov_b32 s54, s70
    s_cmp_lt_u32 s54, s55
    s_mov_b32 s54, 0xffff
    s_cbranch_scc0 L_nc1
    s_mov_b32 s54, 1
    s_atomic_add s54, s[84:85], 0 glc
L_nc1:
    s_lshl_b32 s34, s25, 14
    s_lshl_b32 s35, s26, 11
    s_add_u32 s34, s34, s35
    s_add_u32 s62, s34, 131072
    s_setprio 1
    s_cmp_lt_u32 s3, 4
    s_cbranch_scc0 L_yp
    s_setprio 0
L_yp:
    s_waitcnt lgkmcnt(0)
    s_cmp_lt_u32 s54, 144
    s_cbranch_scc0 L_qpoll
    s_lshl_b32 s32, s54, 13
    s_add_u32 s32, s32, s30
    s_waitcnt vmcnt(15)
    buffer_load_dwordx4 v[192:195], v5, s[4:7], s32 offen offset:0 nt
    s_waitcnt vmcnt(15)
    buffer_load_dwordx4 v[196:199], v5, s[4:7], s32 offen offset:256 nt
    s_waitcnt vmcnt(15)
    buffer_load_dwordx4 v[200:203], v5, s[4:7], s32 offen offset:512 nt
    s_waitcnt vmcnt(15)
    buffer_load_dwordx4 v[204:207], v5, s[4:7], s32 offen offset:768 nt
    s_waitcnt vmcnt(15)
    buffer_load_dwordx4 v[208:211], v5, s[4:7], s32 offen offset:1024 nt
    s_waitcnt vmcnt(15)
    buffer_load_dwordx4 v[212:215], v5, s[4:7], s32 offen offset:1280 nt
    s_waitcnt vmcnt(15)
    buffer_load_dwordx4 v[216:219], v5, s[4:7], s32 offen offset:1536 nt
    s_waitcnt vmcnt(15)
    buffer_load_dwordx4 v[220:223], v5, s[4:7], s32 offen offset:1792 nt
    buffer_load_dwordx4 v[16:19], v6, s[12:15], s62 offen offset:0 sc1
    buffer_load_dwordx4 v[20:23], v6, s[12:15], s62 offen offset:1024 sc1
    s_waitcnt vmcnt(15)
    buffer_load_dwordx4 v[224:227], v0, s[8:11], s32 offen offset:0 nt
    s_waitcnt vmcnt(15)
    buffer_load_dwordx4 v[240:243], v0, s[8:11], s32 offen offset:256 nt
    s_waitcnt vmcnt(15)
    buffer_load_dwordx4 v[228:231], v0, s[8:11], s32 offen offset:512 nt
    s_waitcnt vmcnt(15)
    buffer_load_dwordx4 v[244:247], v0, s[8:11], s32 offen offset:768 nt
    s_waitcnt vmcnt(15)
    buffer_load_dwordx4 v[232:235], v0, s[8:11], s32 offen offset:1024 nt
    s_waitcnt vmcnt(15)
    buffer_load_dwordx4 v[248:251], v0, s[8:11], s32 offen offset:1280 nt
    s_waitcnt vmcnt(15)
    buffer_load_dwordx4 v[236:239], v0, s[8:11], s32 offen offset:1536 nt
    s_waitcnt vmcnt(15)
    buffer_load_dwordx4 v[252:255], v0, s[8:11], s32 offen offset:1792 nt
    s_waitcnt vmcnt(8)
    s_branch L_qchk
L_qpoll:
    buffer_load_dwordx4 v[16:19], v6, s[12:15], s62 offen offset:0 sc1
    buffer_load_dwordx4 v[20:23], v6, s[12:15], s62 offen offset:1024 sc1
L_qwait:
    s_waitcnt vmcnt(0)
L_qchk:
    v_xor_b32 v9, s28, v19
    v_bitop3_b32 v9, v9, v23, s28 bitop3:0xf6
    v_cmp_ne_u32 vcc, 0, v9
    s_cbranch_vccz L_ok_1
    s_sub_u32 s29, s29, 1
    s_cbranch_scc0 L_qpoll
    s_mov_b32 s29, 0
L_ok_1:
    v_lshlrev_b32 v11, 3, v1
    v_add_u32 v11, 73728, v11
    ds_write_b64 v11, v[16:17]
    ds_write_b64 v11, v[20:21] offset:512
    v_bfe_u32 v9, v2, 2, 1
    v_lshlrev_b32 v9, 9, v9
    v_lshl_add_u32 v9, v3, 6, v9
    v_and_b32 v10, 3, v1
    v_lshl_add_u32 v9, v10, 4, v9
    v_add_u32 v9, 73728, v9
    ds_read_b128 v[48:51], v9
    ds_read_b128 v[52:55], v9 offset:256
    s_waitcnt lgkmcnt(0)
    v_cndmask_b32 v56, 0, v48, s[52:53]
    v_cndmask_b32 v57, 0, v49, s[52:53]
    v_cndmask_b32 v58, 0, v50, s[52:53]
    v_cndmask_b32 v59, 0, v51, s[52:53]
    v_cndmask_b32 v60, 0, v52, s[52:53]
    v_cndmask_b32 v61, 0, v53, s[52:53]
    v_cndmask_b32 v62, 0, v54, s[52:53]
    v_cndmask_b32 v63, 0, v55, s[52:53]
    v_cndmask_b32 v48, v48, 0, s[52:53]
    v_cndmask_b32 v49, v49, 0, s[52:53]
    v_cndmask_b32 v50, v50, 0, s[52:53]
    v_cndmask_b32 v51, v51, 0, s[52:53]
    v_cndmask_b32 v52, v52, 0, s[52:53]
    v_cndmask_b32 v53, v53, 0, s[52:53]
    v_cndmask_b32 v54, v54, 0, s[52:53]
    v_cndmask_b32 v55, v55, 0, s[52:53]
    s_nop 1
    v_mfma_f32_16x16x32_bf16 v[16:19], v[48:51], v[128:131], 0
    v_mfma_f32_16x16x32_bf16 v[16:19], v[52:55], v[132:135], v[16:19]
    v_mfma_f32_16x16x32_bf16 v[16:19], v[56:59], v[136:139], v[16:19]
    v_mfma_f32_16x16x32_bf16 v[16:19], v[60:63], v[140:143], v[16:19]
    v_mfma_f32_16x16x32_bf16 v[20:23], v[48:51], v[144:147], 0
    v_mfma_f32_16x16x32_bf16 v[20:23], v[52:55], v[148:151], v[20:23]
    v_mfma_f32_16x16x32_bf16 v[20:23], v[56:59], v[152:155], v[20:23]
    v_mfma_f32_16x16x32_bf16 v[20:23], v[60:63], v[156:159], v[20:23]
    v_mfma_f32_16x16x32_bf16 v[24:27], v[48:51], v[160:163], 0
    v_mfma_f32_16x16x32_bf16 v[24:27], v[52:55], v[164:167], v[24:27]
    v_mfma_f32_16x16x32_bf16 v[24:27], v[56:59], v[168:171], v[24:27]
    v_mfma_f32_16x16x32_bf16 v[24:27], v[60:63], v[172:175], v[24:27]
    v_mfma_f32_16x16x32_bf16 v[28:31], v[48:51], v[176:179], 0
    v_mfma_f32_16x16x32_bf16 v[28:31], v[52:55], v[180:183], v[28:31]
    v_mfma_f32_16x16x32_bf16 v[28:31], v[56:59], v[184:187], v[28:31]
    v_mfma_f32_16x16x32_bf16 v[28:31], v[60:63], v[188:191], v[28:31]
    v_and_b32 v12, 1, v3
    v_and_b32 v9, 1, v1
    v_lshrrev_b32 v13, 1, v3
    v_lshl_add_u32 v182, v9, 1, v13
    v_lshrrev_b32 v13, 2, v2
    v_lshl_add_u32 v182, v13, 2, v182
    v_lshlrev_b32 v182, 1, v182
    v_lshl_add_u32 v182, v12, 7, v182
    s_lshl_b32 s34, s3, 9
    s_add_u32 s34, s34, 74752
    v_lshlrev_b32 v183, 7, v13
    v_add_u32 v182, s34, v182
    v_bfe_u32 v13, v1, 1, 1
    v_lshl_add_u32 v13, v13, 5, v182
    v_add_u32 v183, s34, v183
    v_lshl_add_u32 v12, v3, 4, v183
    v_lshl_add_u32 v183, v3, 3, v183
    s_mov_b32 s52, 0xaaaaaaaa
    s_mov_b32 s53, 0xaaaaaaaa
    v_cndmask_b32 v16, v16, v17, s[46:47]
    v_cndmask_b32 v16, v16, v18, s[48:49]
    v_cndmask_b32 v16, v16, v19, s[50:51]
    v_cndmask_b32 v20, v20, v21, s[46:47]
    v_cndmask_b32 v20, v20, v22, s[48:49]
    v_cndmask_b32 v20, v20, v23, s[50:51]
    v_cndmask_b32 v24, v24, v25, s[46:47]
    v_cndmask_b32 v24, v24, v26, s[48:49]
    v_cndmask_b32 v24, v24, v27, s[50:51]
    v_cndmask_b32 v28, v28, v29, s[46:47]
    v_cndmask_b32 v28, v28, v30, s[48:49]
    v_cndmask_b32 v28, v28, v31, s[50:51]
    v_add_f32 v16, v16, v16 quad_perm:[1,0,3,2] row_mask:0xf bank_mask:0xf
    v_add_f32 v20, v20, v20 quad_perm:[1,0,3,2] row_mask:0xf bank_mask:0xf
    v_add_f32 v24, v24, v24 quad_perm:[1,0,3,2] row_mask:0xf bank_mask:0xf
    v_add_f32 v28, v28, v28 quad_perm:[1,0,3,2] row_mask:0xf bank_mask:0xf
    v_add_f32 v16, v16, v16 quad_perm:[2,3,0,1] row_mask:0xf bank_mask:0xf
    v_add_f32 v20, v20, v20 quad_perm:[2,3,0,1] row_mask:0xf bank_mask:0xf
    v_add_f32 v24, v24, v24 quad_perm:[2,3,0,1] row_mask:0xf bank_mask:0xf
    v_add_f32 v28, v28, v28 quad_perm:[2,3,0,1] row_mask:0xf bank_mask:0xf
    v_cndmask_b32 v10, v16, v20, s[46:47]
    v_cndmask_b32 v10, v10, v24, s[48:49]
    v_cndmask_b32 v10, v10, v28, s[50:51]
    v_cvt_pk_bf16_f32 v10, v10, v10
    v_lshlrev_b32 v10, 16, v10
    v_mov_b32 v14, v10
    s_nop 1
    v_max_f32 v14, v14, v14 quad_perm:[1,0,3,2] row_mask:0xf bank_mask:0xf
    s_nop 1
    v_max_f32 v14, v14, v14 quad_perm:[2,3,0,1] row_mask:0xf bank_mask:0xf
    s_nop 1
    v_max_f32 v14, v14, v14 row_half_mirror row_mask:0xf bank_mask:0xf
    s_nop 1
    v_max_f32 v14, v14, v14 row_mirror row_mask:0xf bank_mask:0xf
    v_mov_b32 v17, v14
    s_nop 1
    v_permlane32_swap_b32 v14, v17
    v_max_f32 v14, v14, v17
    v_sub_f32 v10, v10, v14
    v_mul_f32 v10, s59, v10
    v_exp_f32 v15, v10
    s_nop 0
    v_cvt_pk_bf16_f32 v20, v15, v15
    v_lshlrev_b32 v20, 16, v20
    v_sub_f32 v20, v15, v20
    v_cvt_pk_bf16_f32 v20, v15, v20
    ds_write_b16 v13, v20
    ds_write_b16_d16_hi v13, v20 offset:256
    ds_read_b128 v[176:179], v12
    s_waitcnt lgkmcnt(0)
    v_perm_b32 v160, v68, v64, s57
    v_perm_b32 v161, v76, v72, s57
    v_perm_b32 v162, v84, v80, s57
    v_perm_b32 v163, v92, v88, s57
    v_perm_b32 v164, v68, v64, s58
    v_perm_b32 v165, v76, v72, s58
    v_perm_b32 v166, v84, v80, s58
    v_perm_b32 v167, v92, v88, s58
    s_nop 0
    v_mfma_f32_16x16x32_bf16 v[16:19], v[176:179], v[160:163], 0
    v_mfma_f32_16x16x32_bf16 v[20:23], v[176:179], v[164:167], 0
    v_perm_b32 v168, v69, v65, s57
    v_perm_b32 v169, v77, v73, s57
    v_perm_b32 v170, v85, v81, s57
    v_perm_b32 v171, v93, v89, s57
    v_perm_b32 v172, v69, v65, s58
    v_perm_b32 v173, v77, v73, s58
    v_perm_b32 v174, v85, v81, s58
    v_perm_b32 v175, v93, v89, s58
    s_nop 0
    v_mfma_f32_16x16x32_bf16 v[24:27], v[176:179], v[168:171], 0
    v_mfma_f32_16x16x32_bf16 v[28:31], v[176:179], v[172:175], 0
    v_perm_b32 v160, v70, v66, s57
    v_perm_b32 v161, v78, v74, s57
    v_perm_b32 v162, v86, v82, s57
    v_perm_b32 v163, v94, v90, s57
    v_perm_b32 v164, v70, v66, s58
    v_perm_b32 v165, v78, v74, s58
    v_perm_b32 v166, v86, v82, s58
    v_perm_b32 v167, v94, v90, s58
    s_nop 0
    v_mfma_f32_16x16x32_bf16 v[32:35], v[176:179], v[160:163], 0
    v_mfma_f32_16x16x32_bf16 v[36:39], v[176:179], v[164:167], 0
    v_perm_b32 v168, v71, v67, s57
    v_perm_b32 v169, v79, v75, s57
    v_perm_b32 v170, v87, v83, s57
    v_perm_b32 v171, v95, v91, s57
    v_perm_b32 v172, v71, v67, s58
    v_perm_b32 v173, v79, v75, s58
    v_perm_b32 v174, v87, v83, s58
    v_perm_b32 v175, v95, v91, s58
    s_nop 0
    v_mfma_f32_16x16x32_bf16 v[40:43], v[176:179], v[168:171], 0
    v_mfma_f32_16x16x32_bf16 v[44:47], v[176:179], v[172:175], 0
    v_perm_b32 v160, v100, v96, s57
    v_perm_b32 v161, v108, v104, s57
    v_perm_b32 v162, v116, v112, s57
    v_perm_b32 v163, v124, v120, s57
    v_perm_b32 v164, v100, v96, s58
    v_perm_b32 v165, v108, v104, s58
    v_perm_b32 v166, v116, v112, s58
    v_perm_b32 v167, v124, v120, s58
    s_nop 0
    v_mfma_f32_16x16x32_bf16 v[128:131], v[176:179], v[160:163], 0
    v_mfma_f32_16x16x32_bf16 v[132:135], v[176:179], v[164:167], 0
    v_perm_b32 v168, v101, v97, s57
    v_perm_b32 v169, v109, v105, s57
    v_perm_b32 v170, v117, v113, s57
    v_perm_b32 v171, v125, v121, s57
    v_perm_b32 v172, v101, v97, s58
    v_perm_b32 v173, v109, v105, s58
    v_perm_b32 v174, v117, v113, s58
    v_perm_b32 v175, v125, v121, s58
    s_nop 0
    v_mfma_f32_16x16x32_bf16 v[136:139], v[176:179], v[168:171], 0
    v_mfma_f32_16x16x32_bf16 v[140:143], v[176:179], v[172:175], 0
    v_perm_b32 v160, v102, v98, s57
    v_perm_b32 v161, v110, v106, s57
    v_perm_b32 v162, v118, v114, s57
    v_perm_b32 v163, v126, v122, s57
    v_perm_b32 v164, v102, v98, s58
    v_perm_b32 v165, v110, v106, s58
    v_perm_b32 v166, v118, v114, s58
    v_perm_b32 v167, v126, v122, s58
    s_nop 0
    v_mfma_f32_16x16x32_bf16 v[144:147], v[176:179], v[160:163], 0
    v_mfma_f32_16x16x32_bf16 v[148:151], v[176:179], v[164:167], 0
    v_perm_b32 v168, v103, v99, s57
    v_perm_b32 v169, v111, v107, s57
    v_perm_b32 v170, v119, v115, s57
    v_perm_b32 v171, v127, v123, s57
    v_perm_b32 v172, v103, v99, s58
    v_perm_b32 v173, v111, v107, s58
    v_perm_b32 v174, v119, v115, s58
    v_perm_b32 v175, v127, v123, s58
    s_nop 0
    v_mfma_f32_16x16x32_bf16 v[152:155], v[176:179], v[168:171], 0
    v_mfma_f32_16x16x32_bf16 v[156:159], v[176:179], v[172:175], 0
    v_and_b32 v12, 1, v3
    v_lshlrev_b32 v80, 6, v12
    s_lshl_b32 s33, s3, 3
    s_add_u32 s33, s33, 124736
    v_add_u32 v80, s33, v80
    s_bfe_u32 s33, s3, 0x10001
    s_lshl_b32 s33, s33, 6
    s_add_u32 s33, s33, 124736
    v_and_b32 v81, 7, v1
    v_lshl_add_u32 v81, v81, 3, s33
    v_lshlrev_b32 v78, 10, v12
    v_lshl_add_u32 v78, v2, 5, v78
    v_lshrrev_b32 v12, 1, v3
    v_lshl_add_u32 v78, v12, 4, v78
    s_lshl_b32 s34, s3, 11
    s_add_u32 s34, s34, 57344
    v_add_u32 v78, s34, v78
    s_and_b32 s35, s3, 3
    s_lshl_b32 s33, s35, 9
    s_add_u32 s33, s33, 57344
    v_lshl_add_u32 v79, v1, 3, s33
    v_lshrrev_b32 v82, 5, v1
    v_mul_u32_u24 v82, 3584, v82
    v_add_u32 v82, v82, v6
    s_lshl_b32 s66, s63, 15
    s_lshl_b32 s34, s35, 13
    s_add_u32 s66, s66, s34
    s_lshl_b32 s34, s24, 9
    s_add_u32 s66, s66, s34
    s_add_u32 s66, s66, 196608
    v_mov_b32 v87, s28
    s_cmp_lt_u32 s54, 144
    s_cbranch_scc1 L_top
    s_nop 1
    v_add_f32 v15, v15, v15 quad_perm:[1,0,3,2] row_mask:0xf bank_mask:0xf
    s_nop 1
    v_add_f32 v15, v15, v15 quad_perm:[2,3,0,1] row_mask:0xf bank_mask:0xf
    s_nop 1
    v_add_f32 v15, v15, v15 row_half_mirror row_mask:0xf bank_mask:0xf
    s_nop 1
    v_add_f32 v15, v15, v15 row_mirror row_mask:0xf bank_mask:0xf
    v_mov_b32 v12, v15
    s_nop 1
    v_permlane32_swap_b32 v15, v12
    v_add_f32 v15, v15, v12
    ds_write_b64 v80, v[14:15]
    s_branch L_exit2
L_top:
    s_waitcnt vmcnt(10)
    s_cmp_lt_u32 s54, s55
    s_mov_b32 s54, 0xffff
    s_cbranch_scc0 L_nc2
    s_mov_b32 s54, 1
    s_atomic_add s54, s[84:85], 0 glc
L_nc2:
    s_waitcnt vmcnt(8)
    v_mfma_f32_16x16x32_bf16 v[184:187], v[48:51], v[192:195], 0
    v_mfma_f32_16x16x32_bf16 v[184:187], v[52:55], v[196:199], v[184:187]
    v_mfma_f32_16x16x32_bf16 v[184:187], v[56:59], v[200:203], v[184:187]
    v_mfma_f32_16x16x32_bf16 v[184:187], v[60:63], v[204:207], v[184:187]
    v_mfma_f32_16x16x32_bf16 v[188:191], v[48:51], v[208:211], 0
    v_mfma_f32_16x16x32_bf16 v[188:191], v[52:55], v[212:215], v[188:191]
    v_mfma_f32_16x16x32_bf16 v[188:191], v[56:59], v[216:219], v[188:191]
    v_mfma_f32_16x16x32_bf16 v[188:191], v[60:63], v[220:223], v[188:191]
    s_nop 4
    v_cndmask_b32 v184, v184, v185, s[46:47]
    v_cndmask_b32 v184, v184, v186, s[48:49]
    v_cndmask_b32 v184, v184, v187, s[50:51]
    v_cndmask_b32 v188, v188, v189, s[46:47]
    v_cndmask_b32 v188, v188, v190, s[48:49]
    v_cndmask_b32 v188, v188, v191, s[50:51]
    s_nop 0
    v_add_f32 v184, v184, v184 quad_perm:[1,0,3,2] row_mask:0xf bank_mask:0xf
    v_add_f32 v188, v188, v188 quad_perm:[1,0,3,2] row_mask:0xf bank_mask:0xf
    s_nop 0
    v_add_f32 v184, v184, v184 quad_perm:[2,3,0,1] row_mask:0xf bank_mask:0xf
    v_add_f32 v188, v188, v188 quad_perm:[2,3,0,1] row_mask:0xf bank_mask:0xf
    v_cndmask_b32 v11, v184, v188, s[52:53]
    v_cvt_pk_bf16_f32 v11, v11, v11
    v_lshlrev_b32 v11, 16, v11
    v_max_f32 v10, v11, v14
    s_nop 1
    v_max_f32 v10, v10, v10 quad_perm:[1,0,3,2] row_mask:0xf bank_mask:0xf
    s_nop 1
    v_max_f32 v10, v10, v10 row_half_mirror row_mask:0xf bank_mask:0xf
    s_nop 1
    v_max_f32 v10, v10, v10 row_mirror row_mask:0xf bank_mask:0xf
    v_mov_b32 v12, v10
    s_nop 1
    v_permlane32_swap_b32 v10, v12
    v_max_f32 v10, v10, v12
    v_sub_f32 v11, v11, v10
    v_sub_f32 v12, v14, v10
    v_cmp_neq_f32 vcc, v14, v10
    v_mul_f32 v11, s59, v11
    v_mul_f32 v12, s59, v12
    v_exp_f32 v11, v11
    v_exp_f32 v12, v12
    v_mov_b32 v14, v10
    v_cvt_pk_bf16_f32 v13, v11, v11
    v_mul_f32 v15, v15, v12
    v_lshlrev_b32 v13, 16, v13
    v_sub_f32 v13, v11, v13
    v_cvt_pk_bf16_f32 v13, v11, v13
    ds_write_b16 v182, v13 offset:64
    ds_write_b16_d16_hi v182, v13 offset:320
    ds_read_b64 v[180:181], v183 offset:64
    v_fma_f32 v15, v11, 0.5, v15
    s_cbranch_vccz L_nors
    v_mul_f32 v16, v16, v12
    v_mul_f32 v20, v20, v12
    v_mul_f32 v24, v24, v12
    v_mul_f32 v28, v28, v12
    v_mul_f32 v32, v32, v12
    v_mul_f32 v36, v36, v12
    v_mul_f32 v40, v40, v12
    v_mul_f32 v44, v44, v12
    v_mul_f32 v128, v128, v12
    v_mul_f32 v132, v132, v12
    v_mul_f32 v136, v136, v12
    v_mul_f32 v140, v140, v12
    v_mul_f32 v144, v144, v12
    v_mul_f32 v148, v148, v12
    v_mul_f32 v152, v152, v12
    v_mul_f32 v156, v156, v12
L_nors:
    s_waitcnt lgkmcnt(0)
    s_cmp_lt_u32 s54, 144
    s_cbranch_scc0 L_last
    s_lshl_b32 s32, s54, 13
    s_add_u32 s32, s32, s30
    buffer_load_dwordx4 v[192:195], v5, s[4:7], s32 offen offset:0 nt
    buffer_load_dwordx4 v[196:199], v5, s[4:7], s32 offen offset:256 nt
    buffer_load_dwordx4 v[200:203], v5, s[4:7], s32 offen offset:512 nt
    buffer_load_dwordx4 v[204:207], v5, s[4:7], s32 offen offset:768 nt
    buffer_load_dwordx4 v[208:211], v5, s[4:7], s32 offen offset:1024 nt
    buffer_load_dwordx4 v[212:215], v5, s[4:7], s32 offen offset:1280 nt
    buffer_load_dwordx4 v[216:219], v5, s[4:7], s32 offen offset:1536 nt
    buffer_load_dwordx4 v[220:223], v5, s[4:7], s32 offen offset:1792 nt
L_pv:
    s_waitcnt vmcnt(8)
    v_perm_b32 v160, v228, v224, s57
    v_perm_b32 v161, v236, v232, s57
    v_perm_b32 v162, v228, v224, s58
    v_perm_b32 v163, v236, v232, s58
    v_perm_b32 v164, v229, v225, s57
    v_perm_b32 v165, v237, v233, s57
    v_perm_b32 v166, v229, v225, s58
    v_perm_b32 v167, v237, v233, s58
    v_perm_b32 v168, v230, v226, s57
    v_perm_b32 v169, v238, v234, s57
    v_perm_b32 v170, v230, v226, s58
    v_perm_b32 v171, v238, v234, s58
    v_perm_b32 v172, v231, v227, s57
    v_perm_b32 v173, v239, v235, s57
    v_perm_b32 v174, v231, v227, s58
    v_perm_b32 v175, v239, v235, s58
    v_mfma_f32_16x16x16_bf16 v[16:19], v[180:181], v[160:161], v[16:19]
    v_mfma_f32_16x16x16_bf16 v[20:23], v[180:181], v[162:163], v[20:23]
    v_mfma_f32_16x16x16_bf16 v[24:27], v[180:181], v[164:165], v[24:27]
    v_mfma_f32_16x16x16_bf16 v[28:31], v[180:181], v[166:167], v[28:31]
    v_mfma_f32_16x16x16_bf16 v[32:35], v[180:181], v[168:169], v[32:35]
    v_mfma_f32_16x16x16_bf16 v[36:39], v[180:181], v[170:171], v[36:39]
    v_mfma_f32_16x16x16_bf16 v[40:43], v[180:181], v[172:173], v[40:43]
    v_mfma_f32_16x16x16_bf16 v[44:47], v[180:181], v[174:175], v[44:47]
    v_perm_b32 v160, v244, v240, s57
    v_perm_b32 v161, v252, v248, s57
    v_perm_b32 v162, v244, v240, s58
    v_perm_b32 v163, v252, v248, s58
    v_perm_b32 v164, v245, v241, s57
    v_perm_b32 v165, v253, v249, s57
    v_perm_b32 v166, v245, v241, s58
    v_perm_b32 v167, v253, v249, s58
    v_perm_b32 v168, v246, v242, s57
    v_perm_b32 v169, v254, v250, s57
    v_perm_b32 v170, v246, v242, s58
    v_perm_b32 v171, v254, v250, s58
    v_perm_b32 v172, v247, v243, s57
    v_perm_b32 v173, v255, v251, s57
    v_perm_b32 v174, v247, v243, s58
    v_perm_b32 v175, v255, v251, s58
    v_mfma_f32_16x16x16_bf16 v[128:131], v[180:181], v[160:161], v[128:131]
    v_mfma_f32_16x16x16_bf16 v[132:135], v[180:181], v[162:163], v[132:135]
    v_mfma_f32_16x16x16_bf16 v[136:139], v[180:181], v[164:165], v[136:139]
    v_mfma_f32_16x16x16_bf16 v[140:143], v[180:181], v[166:167], v[140:143]
    v_mfma_f32_16x16x16_bf16 v[144:147], v[180:181], v[168:169], v[144:147]
    v_mfma_f32_16x16x16_bf16 v[148:151], v[180:181], v[170:171], v[148:151]
    v_mfma_f32_16x16x16_bf16 v[152:155], v[180:181], v[172:173], v[152:155]
    v_mfma_f32_16x16x16_bf16 v[156:159], v[180:181], v[174:175], v[156:159]
    s_cmp_lt_u32 s54, 144
    s_cbranch_scc0 L_exit
    buffer_load_dwordx4 v[224:227], v0, s[8:11], s32 offen offset:0 nt
    buffer_load_dwordx4 v[240:243], v0, s[8:11], s32 offen offset:256 nt
    buffer_load_dwordx4 v[228:231], v0, s[8:11], s32 offen offset:512 nt
    buffer_load_dwordx4 v[244:247], v0, s[8:11], s32 offen offset:768 nt
    buffer_load_dwordx4 v[232:235], v0, s[8:11], s32 offen offset:1024 nt
    buffer_load_dwordx4 v[248:251], v0, s[8:11], s32 offen offset:1280 nt
    buffer_load_dwordx4 v[236:239], v0, s[8:11], s32 offen offset:1536 nt
    buffer_load_dwordx4 v[252:255], v0, s[8:11], s32 offen offset:1792 nt
    s_branch L_top
L_last:
    s_nop 1
    v_add_f32 v15, v15, v15 quad_perm:[1,0,3,2] row_mask:0xf bank_mask:0xf
    s_nop 1
    v_add_f32 v15, v15, v15 quad_perm:[2,3,0,1] row_mask:0xf bank_mask:0xf
    s_nop 1
    v_add_f32 v15, v15, v15 row_half_mirror row_mask:0xf bank_mask:0xf
    s_nop 1
    v_add_f32 v15, v15, v15 row_mirror row_mask:0xf bank_mask:0xf
    v_mov_b32 v12, v15
    s_nop 1
    v_permlane32_swap_b32 v15, v12
    v_add_f32 v15, v15, v12
    ds_write_b64 v80, v[14:15]
L_last2:
    s_waitcnt vmcnt(0)
    s_branch L_pv
L_exit:
L_exit2:
    v_permlane32_swap_b32 v16, v32
    v_permlane32_swap_b32 v20, v36
    v_permlane32_swap_b32 v24, v40
    v_permlane32_swap_b32 v28, v44
    v_add_f32 v88, v16, v32
    v_add_f32 v89, v20, v36
    v_add_f32 v90, v24, v40
    v_add_f32 v91, v28, v44
    ds_write_b128 v78, v[88:91] offset:0
    v_permlane32_swap_b32 v128, v144
    v_permlane32_swap_b32 v132, v148
    v_permlane32_swap_b32 v136, v152
    v_permlane32_swap_b32 v140, v156
    v_add_f32 v92, v128, v144
    v_add_f32 v93, v132, v148
    v_add_f32 v94, v136, v152
    v_add_f32 v95, v140, v156
    ds_write_b128 v78, v[92:95] offset:512
    s_cmp_lt_u32 s3, 4
    s_waitcnt lgkmcnt(0)
    s_cbranch_scc0 L_mlspin
    s_barrier
    s_branch L_fin
L_mls:
    s_sleep 2
L_mlspin:
    ds_read_b64 v[32:33], v81
    s_waitcnt lgkmcnt(0)
    v_cmp_eq_u32 vcc, 0, v33
    s_cbranch_vccz L_ok_2
    s_sub_u32 s29, s29, 1
    s_cbranch_scc0 L_mls
    s_mov_b32 s29, 0
L_ok_2:
    v_max_f32 v34, v32, v32 quad_perm:[1,0,3,2] row_mask:0xf bank_mask:0xf
    s_nop 1
    v_max_f32 v34, v34, v34 quad_perm:[2,3,0,1] row_mask:0xf bank_mask:0xf
    s_nop 1
    v_max_f32 v34, v34, v34 row_half_mirror row_mask:0xf bank_mask:0xf
    v_sub_f32 v32, v32, v34
    v_mul_f32 v32, s59, v32
    v_exp_f32 v32, v32
    s_nop 0
    v_mul_f32 v33, v33, v32
    s_nop 1
    v_add_f32 v33, v33, v33 quad_perm:[1,0,3,2] row_mask:0xf bank_mask:0xf
    s_nop 1
    v_add_f32 v33, v33, v33 quad_perm:[2,3,0,1] row_mask:0xf bank_mask:0xf
    s_nop 1
    v_add_f32 v33, v33, v33 row_half_mirror row_mask:0xf bank_mask:0xf
    v_rcp_f32 v36, v33
    v_log_f32 v86, v33
    v_mul_f32 v32, v32, v36
    v_fma_f32 v86, v34, s59, v86
    v_readlane_b32 s4, v32, 0
    v_readlane_b32 s5, v32, 1
    v_readlane_b32 s6, v32, 2
    v_readlane_b32 s7, v32, 3
    v_readlane_b32 s8, v32, 4
    v_readlane_b32 s9, v32, 5
    v_readlane_b32 s10, v32, 6
    v_readlane_b32 s11, v32, 7
    s_barrier
    ds_read_b64 v[24:25], v79 offset:8192
    ds_read_b64 v[26:27], v79 offset:10240
    ds_read_b64 v[28:29], v79 offset:12288
    ds_read_b64 v[30:31], v79 offset:14336
    ds_read_b64 v[16:17], v79 offset:0
    ds_read_b64 v[18:19], v79 offset:2048
    ds_read_b64 v[20:21], v79 offset:4096
    ds_read_b64 v[22:23], v79 offset:6144
    s_waitcnt lgkmcnt(7)
    v_pk_mul_f32 v[36:37], v[24:25], s[8:9] op_sel_hi:[1,0]
    s_waitcnt lgkmcnt(6)
    v_pk_mul_f32 v[38:39], v[26:27], s[8:9] op_sel:[0,1] op_sel_hi:[1,1]
    s_waitcnt lgkmcnt(5)
    v_pk_fma_f32 v[36:37], v[28:29], s[10:11], v[36:37] op_sel_hi:[1,0,1]
    s_waitcnt lgkmcnt(4)
    v_pk_fma_f32 v[38:39], v[30:31], s[10:11], v[38:39] op_sel:[0,1,0] op_sel_hi:[1,1,1]
    s_waitcnt lgkmcnt(3)
    v_pk_fma_f32 v[36:37], v[16:17], s[4:5], v[36:37] op_sel_hi:[1,0,1]
    s_waitcnt lgkmcnt(2)
    v_pk_fma_f32 v[38:39], v[18:19], s[4:5], v[38:39] op_sel:[0,1,0] op_sel_hi:[1,1,1]
    s_waitcnt lgkmcnt(1)
    v_pk_fma_f32 v[36:37], v[20:21], s[6:7], v[36:37] op_sel_hi:[1,0,1]
    s_waitcnt lgkmcnt(0)
    v_pk_fma_f32 v[38:39], v[22:23], s[6:7], v[38:39] op_sel:[0,1,0] op_sel_hi:[1,1,1]
    v_pk_add_f32 v[84:85], v[36:37], v[38:39]
    buffer_store_dwordx4 v[84:87], v82, s[12:15], s66 offen sc1
    s_branch L_fin
L_svc:
    v_mov_b32 v255, 0
    v_mov_b32 v239, 0
    v_mov_b32 v4, v10
    v_mov_b32 v5, v11
    s_and_b32 s25, s3, 3
    s_mov_b32 s16, s70
    s_mov_b32 s17, s71
    s_mov_b32 s18, 3670016
    s_mov_b32 s19, 0x20000
    s_mov_b32 s33, 8192
    v_mad_u32_u24 v7, v4, s33, v5
    s_mov_b32 s55, 65536
    s_mul_i32 s54, s3, 458752
    s_lshl_b32 s33, s27, 8
    s_add_u32 s54, s54, s33
    s_add_u32 s54, s54, 128
    s_mul_i32 s56, s3, 7168
    s_add_u32 s56, s56, 57360
    s_mov_b32 m0, s56
    s_add_u32 s56, s56, 1024
    buffer_load_dwordx4 v7, s[16:19], s54 offen nt lds
    s_add_u32 s54, s54, s55
    v_xor_b32 v7, 64, v7
    s_mov_b32 m0, s56
    s_add_u32 s56, s56, 1024
    buffer_load_dwordx4 v7, s[16:19], s54 offen nt lds
    s_add_u32 s54, s54, s55
    v_xor_b32 v7, 64, v7
    s_mov_b32 m0, s56
    s_add_u32 s56, s56, 1024
    buffer_load_dwordx4 v7, s[16:19], s54 offen nt lds
    s_add_u32 s54, s54, s55
    v_xor_b32 v7, 64, v7
    s_mov_b32 m0, s56
    s_add_u32 s56, s56, 1024
    buffer_load_dwordx4 v7, s[16:19], s54 offen nt lds
    s_add_u32 s54, s54, s55
    v_xor_b32 v7, 64, v7
    s_mov_b32 m0, s56
    s_add_u32 s56, s56, 1024
    buffer_load_dwordx4 v7, s[16:19], s54 offen nt lds
    s_add_u32 s54, s54, s55
    v_xor_b32 v7, 64, v7
    s_mov_b32 m0, s56
    s_add_u32 s56, s56, 1024
    buffer_load_dwordx4 v7, s[16:19], s54 offen nt lds
    s_add_u32 s54, s54, s55
    v_xor_b32 v7, 64, v7
    s_mov_b32 m0, s56
    s_add_u32 s56, s56, 1024
    buffer_load_dwordx4 v7, s[16:19], s54 offen nt lds
    s_add_u32 s54, s54, s55
    v_xor_b32 v7, 64, v7
    s_mov_b32 s12, s90
    s_mov_b32 s13, s91
    s_mov_b32 s14, 8388608
    s_mov_b32 s15, 0x20000
    s_mov_b32 s44, -1
    s_mov_b32 s45, 0x0000ffff
    s_mov_b32 s60, 0xffff0000
    s_mov_b32 s29, 0x80000
    s_mov_b32 s38, 0xffff0000
    s_mov_b32 s39, 0
    s_mov_b32 s40, 0
    s_mov_b32 s41, 0xffff
    s_mov_b32 s42, 0
    s_mov_b32 s43, 0xffff0000
    s_mov_b32 s46, 0x22222222
    s_mov_b32 s47, 0x22222222
    s_mov_b32 s48, 0x44444444
    s_mov_b32 s49, 0x44444444
    s_mov_b32 s50, 0x88888888
    s_mov_b32 s51, 0x88888888
    s_lshr_b32 s33, s3, 1
    s_mul_i32 s33, s33, 28
    s_add_u32 s33, s33, s27
    s_mul_i32 s33, s33, 2048
    s_and_b32 s34, s3, 1
    s_lshl_b32 s34, s34, 10
    s_add_u32 s33, s33, s34
    s_add_u32 s33, s33, 1245184
    s_cmp_lt_u32 s27, 28
    s_cselect_b32 s33, s33, 8388608
    v_mov_b32 v20, -1
    v_mov_b32 v21, -1
    v_mov_b32 v22, -1
    v_mov_b32 v23, -1
    buffer_store_dwordx4 v[20:23], v6, s[12:15], s33 offen sc1
    v_lshrrev_b32 v10, 2, v2
    v_lshl_add_u32 v10, v3, 3, v10
    s_waitcnt vmcnt(15)
    v_readfirstlane_b32 s28, v8
    s_add_u32 s28, s28, 0x9e3779b9
    s_cmp_lt_u32 s3, 4
    s_cbranch_scc0 L_s2
    v_lshlrev_b32 v24, 16, v16
    v_and_b32 v25, s60, v16
    v_lshlrev_b32 v26, 16, v17
    v_and_b32 v27, s60, v17
    v_lshlrev_b32 v28, 16, v18
    v_and_b32 v29, s60, v18
    v_lshlrev_b32 v30, 16, v19
    v_and_b32 v31, s60, v19
    v_pk_add_f32 v[32:33], v[24:25], v[26:27]
    v_pk_add_f32 v[34:35], v[28:29], v[30:31]
    v_pk_add_f32 v[32:33], v[32:33], v[34:35]
    v_add_f32 v32, v32, v33
    s_nop 1
    v_add_f32 v32, v32, v32 quad_perm:[1,0,3,2] row_mask:0xf bank_mask:0xf
    s_nop 1
    v_add_f32 v32, v32, v32 quad_perm:[2,3,0,1] row_mask:0xf bank_mask:0xf
    s_nop 1
    v_add_f32 v32, v32, v32 row_half_mirror row_mask:0xf bank_mask:0xf
    s_nop 1
    v_add_f32 v32, v32, v32 row_mirror row_mask:0xf bank_mask:0xf
    s_nop 1
    v_add_f32 v32, v32, v32 row_bcast:15 row_mask:0xa bank_mask:0xf
    s_nop 1
    v_add_f32 v32, v32, v32 row_bcast:31 row_mask:0xc bank_mask:0xf
    s_nop 0
    v_readlane_b32 s37, v32, 63
    s_nop 1
    v_mov_b32 v40, 0x3b124925
    v_mul_f32 v32, s37, v40
    v_pk_add_f32 v[34:35], v[24:25], v[32:33] op_sel_hi:[1,0] neg_lo:[0,1] neg_hi:[0,1]
    v_pk_add_f32 v[36:37], v[26:27], v[32:33] op_sel_hi:[1,0] neg_lo:[0,1] neg_hi:[0,1]
    v_pk_mul_f32 v[38:39], v[34:35], v[34:35]
    v_pk_add_f32 v[34:35], v[28:29], v[32:33] op_sel_hi:[1,0] neg_lo:[0,1] neg_hi:[0,1]
    v_pk_fma_f32 v[38:39], v[36:37], v[36:37], v[38:39]
    v_pk_add_f32 v[36:37], v[30:31], v[32:33] op_sel_hi:[1,0] neg_lo:[0,1] neg_hi:[0,1]
    s_mov_b64 exec, s[44:45]
    v_pk_fma_f32 v[38:39], v[34:35], v[34:35], v[38:39]
    v_pk_fma_f32 v[38:39], v[36:37], v[36:37], v[38:39]
    s_mov_b64 exec, -1
    v_add_f32 v38, v38, v39
    v_cvt_pk_bf16_f32 v32, v32, v32
    v_lshlrev_b32 v32, 16, v32
    v_add_f32 v38, v38, v38 quad_perm:[1,0,3,2] row_mask:0xf bank_mask:0xf
    v_pk_add_f32 v[24:25], v[24:25], v[32:33] op_sel_hi:[1,0] neg_lo:[0,1] neg_hi:[0,1]
    v_pk_add_f32 v[26:27], v[26:27], v[32:33] op_sel_hi:[1,0] neg_lo:[0,1] neg_hi:[0,1]
    v_add_f32 v38, v38, v38 quad_perm:[2,3,0,1] row_mask:0xf bank_mask:0xf
    v_pk_add_f32 v[28:29], v[28:29], v[32:33] op_sel_hi:[1,0] neg_lo:[0,1] neg_hi:[0,1]
    v_pk_add_f32 v[30:31], v[30:31], v[32:33] op_sel_hi:[1,0] neg_lo:[0,1] neg_hi:[0,1]
    v_add_f32 v38, v38, v38 row_half_mirror row_mask:0xf bank_mask:0xf
    v_cvt_pk_bf16_f32 v34, v24, v25
    v_lshlrev_b32 v24, 16, v34
    v_add_f32 v38, v38, v38 row_mirror row_mask:0xf bank_mask:0xf
    v_and_b32 v25, s60, v34
    v_cvt_pk_bf16_f32 v34, v26, v27
    v_add_f32 v38, v38, v38 row_bcast:15 row_mask:0xa bank_mask:0xf
    v_lshlrev_b32 v26, 16, v34
    v_and_b32 v27, s60, v34
    v_add_f32 v38, v38, v38 row_bcast:31 row_mask:0xc bank_mask:0xf
    v_cvt_pk_bf16_f32 v34, v28, v29
    v_readlane_b32 s37, v38, 63
    v_lshlrev_b32 v28, 16, v34
    v_and_b32 v29, s60, v34
    v_cvt_pk_bf16_f32 v34, v30, v31
    v_lshlrev_b32 v30, 16, v34
    v_and_b32 v31, s60, v34
    v_mul_f32 v38, s37, v40
    v_cvt_pk_bf16_f32 v38, v38, v38
    v_lshlrev_b32 v38, 16, v38
    v_add_f32 v38, 0x3727c5ac, v38
    v_cvt_pk_bf16_f32 v38, v38, v38
    v_lshlrev_b32 v38, 16, v38
    v_sqrt_f32 v38, v38
    s_nop 0
    v_cvt_pk_bf16_f32 v38, v38, v38
    v_lshlrev_b32 v38, 16, v38
    v_rcp_f32 v38, v38
    s_nop 0
    v_pk_mul_f32 v[24:25], v[24:25], v[38:39] op_sel_hi:[1,0]
    v_pk_mul_f32 v[26:27], v[26:27], v[38:39] op_sel_hi:[1,0]
    v_pk_mul_f32 v[28:29], v[28:29], v[38:39] op_sel_hi:[1,0]
    v_pk_mul_f32 v[30:31], v[30:31], v[38:39] op_sel_hi:[1,0]
    v_cvt_pk_bf16_f32 v9, v24, v25
    v_lshlrev_b32 v24, 16, v9
    v_and_b32 v25, s60, v9
    v_cvt_pk_bf16_f32 v9, v26, v27
    v_lshlrev_b32 v26, 16, v9
    v_and_b32 v27, s60, v9
    v_cvt_pk_bf16_f32 v9, v28, v29
    v_lshlrev_b32 v28, 16, v9
    v_and_b32 v29, s60, v9
    v_cvt_pk_bf16_f32 v9, v30, v31
    v_lshlrev_b32 v30, 16, v9
    v_and_b32 v31, s60, v9
L_s2:
    s_waitcnt vmcnt(0)
    s_barrier
    v_lshlrev_b32 v14, 7, v10
    v_lshl_add_u32 v14, v12, 3, v14
    v_bfe_u32 v9, v1, 3, 2
    v_xor_b32 v9, s25, v9
    v_lshl_add_u32 v14, v9, 5, v14
    s_cmp_lt_u32 s3, 4
    s_cselect_b32 s33, 0, 57360
    v_add_u32 v13, s33, v14
    v_add_u32 v15, 1024, v6
    v_mov_b32 v9, 8388608
    v_cndmask_b32 v15, v9, v15, s[44:45]
    s_cbranch_scc1 L_s_h
    s_cmp_eq_u32 s3, 7
    s_cbranch_scc0 L_s_fr
    s_getreg_b32 s33, hwreg(HW_REG_XCC_ID)
    v_mov_b32 v20, s33
    v_mov_b32 v23, s28
    s_lshl_b32 s34, s27, 4
    s_add_u32 s34, s34, 4096
    s_mov_b64 exec, 1
    buffer_store_dwordx4 v[20:23], v6, s[12:15], s34 offen sc1
    s_mov_b64 exec, -1
L_s_fr:
    ds_read_b64_tr_b16 v[64:65], v13 offset:0
    ds_read_b64_tr_b16 v[66:67], v13 offset:512
    ds_read_b64_tr_b16 v[68:69], v13 offset:4096
    ds_read_b64_tr_b16 v[70:71], v13 offset:4608
    ds_read_b64_tr_b16 v[72:73], v13 offset:8192
    ds_read_b64_tr_b16 v[74:75], v13 offset:8704
    ds_read_b64_tr_b16 v[76:77], v13 offset:12288
    ds_read_b64_tr_b16 v[78:79], v13 offset:12800
    s_waitcnt lgkmcnt(6)
    ds_read_b64_tr_b16 v[80:81], v13 offset:16384
    ds_read_b64_tr_b16 v[82:83], v13 offset:16896
    ds_read_b64_tr_b16 v[84:85], v13 offset:20480
    ds_read_b64_tr_b16 v[86:87], v13 offset:20992
    ds_read_b64_tr_b16 v[88:89], v13 offset:24576
    ds_read_b64_tr_b16 v[90:91], v13 offset:25088
    ds_read_b64_tr_b16 v[92:93], v13 offset:28672
    ds_read_b64_tr_b16 v[94:95], v13 offset:29184
    s_waitcnt lgkmcnt(6)
    ds_read_b64_tr_b16 v[96:97], v13 offset:32768
    ds_read_b64_tr_b16 v[98:99], v13 offset:33280
    ds_read_b64_tr_b16 v[100:101], v13 offset:36864
    ds_read_b64_tr_b16 v[102:103], v13 offset:37376
    ds_read_b64_tr_b16 v[104:105], v13 offset:40960
    ds_read_b64_tr_b16 v[106:107], v13 offset:41472
    ds_read_b64_tr_b16 v[108:109], v13 offset:45056
    ds_read_b64_tr_b16 v[110:111], v13 offset:45568
    s_waitcnt lgkmcnt(6)
    ds_read_b64_tr_b16 v[112:113], v13 offset:49152
    ds_read_b64_tr_b16 v[114:115], v13 offset:49664
    ds_read_b64_tr_b16 v[116:117], v13 offset:53248
    ds_read_b64_tr_b16 v[118:119], v13 offset:53760
    s_branch L_s3
L_s_h:
    s_mul_i32 s61, s25, 10752
    s_add_u32 s61, s61, 24576
    buffer_load_dwordx4 v[32:35], v6, s[12:15], s61 offen offset:0 sc1
    buffer_load_dwordx4 v[36:39], v15, s[12:15], s61 offen offset:0 sc1
    buffer_load_dwordx4 v[40:43], v6, s[12:15], s61 offen offset:1792 sc1
    buffer_load_dwordx4 v[44:47], v15, s[12:15], s61 offen offset:1792 sc1
    ds_read_b64_tr_b16 v[64:65], v13 offset:0
    ds_read_b64_tr_b16 v[66:67], v13 offset:512
    ds_read_b64_tr_b16 v[68:69], v13 offset:4096
    ds_read_b64_tr_b16 v[70:71], v13 offset:4608
    ds_read_b64_tr_b16 v[72:73], v13 offset:8192
    ds_read_b64_tr_b16 v[74:75], v13 offset:8704
    ds_read_b64_tr_b16 v[76:77], v13 offset:12288
    ds_read_b64_tr_b16 v[78:79], v13 offset:12800
    s_waitcnt lgkmcnt(6)
    ds_read_b64_tr_b16 v[80:81], v13 offset:16384
    ds_read_b64_tr_b16 v[82:83], v13 offset:16896
    ds_read_b64_tr_b16 v[84:85], v13 offset:20480
    ds_read_b64_tr_b16 v[86:87], v13 offset:20992
    ds_read_b64_tr_b16 v[88:89], v13 offset:24576
    ds_read_b64_tr_b16 v[90:91], v13 offset:25088
    ds_read_b64_tr_b16 v[92:93], v13 offset:28672
    ds_read_b64_tr_b16 v[94:95], v13 offset:29184
    s_waitcnt lgkmcnt(6)
    ds_read_b64_tr_b16 v[96:97], v13 offset:32768
    ds_read_b64_tr_b16 v[98:99], v13 offset:33280
    ds_read_b64_tr_b16 v[100:101], v13 offset:36864
    ds_read_b64_tr_b16 v[102:103], v13 offset:37376
    ds_read_b64_tr_b16 v[104:105], v13 offset:40960
    ds_read_b64_tr_b16 v[106:107], v13 offset:41472
    ds_read_b64_tr_b16 v[108:109], v13 offset:45056
    ds_read_b64_tr_b16 v[110:111], v13 offset:45568
    s_waitcnt lgkmcnt(6)
    ds_read_b64_tr_b16 v[112:113], v13 offset:49152
    ds_read_b64_tr_b16 v[114:115], v13 offset:49664
    ds_read_b64_tr_b16 v[116:117], v13 offset:53248
    ds_read_b64_tr_b16 v[118:119], v13 offset:53760
    s_branch L_hwait
L_hpoll:
    buffer_load_dwordx4 v[32:35], v6, s[12:15], s61 offen offset:0 sc1
    buffer_load_dwordx4 v[36:39], v15, s[12:15], s61 offen offset:0 sc1
    buffer_load_dwordx4 v[40:43], v6, s[12:15], s61 offen offset:1792 sc1
    buffer_load_dwordx4 v[44:47], v15, s[12:15], s61 offen offset:1792 sc1
L_hwait:
    s_waitcnt vmcnt(0)
    v_xor_b32 v9, s28, v39
    v_bitop3_b32 v9, v9, v47, s28 bitop3:0xf6
    v_cndmask_b32 v9, 0, v9, s[44:45]
    v_bitop3_b32 v9, v9, v35, s28 bitop3:0xf6
    v_bitop3_b32 v9, v9, v43, s28 bitop3:0xf6
    v_cmp_ne_u32 vcc, 0, v9
    s_cbranch_vccz L_ok_3
    s_sub_u32 s29, s29, 1
    s_cbranch_scc0 L_hpoll
    s_mov_b32 s29, 0
L_ok_3:
    v_lshlrev_b32 v16, 16, v32
    v_and_b32 v17, s60, v32
    v_lshlrev_b32 v48, 16, v40
    v_and_b32 v49, s60, v40
    v_lshlrev_b32 v18, 16, v33
    v_and_b32 v19, s60, v33
    v_lshlrev_b32 v50, 16, v41
    v_and_b32 v51, s60, v41
    v_lshlrev_b32 v20, 16, v36
    v_and_b32 v21, s60, v36
    v_lshlrev_b32 v52, 16, v44
    v_and_b32 v53, s60, v44
    v_lshlrev_b32 v22, 16, v37
    v_and_b32 v23, s60, v37
    v_lshlrev_b32 v54, 16, v45
    v_and_b32 v55, s60, v45
    v_add_f32 v48, 1.0, v48
    v_add_f32 v49, 1.0, v49
    v_add_f32 v50, 1.0, v50
    v_add_f32 v51, 1.0, v51
    v_add_f32 v52, 1.0, v52
    v_add_f32 v53, 1.0, v53
    v_add_f32 v54, 1.0, v54
    v_add_f32 v55, 1.0, v55
    v_cvt_pk_bf16_f32 v9, v48, v49
    v_lshlrev_b32 v48, 16, v9
    v_and_b32 v49, s60, v9
    v_cvt_pk_bf16_f32 v9, v50, v51
    v_lshlrev_b32 v50, 16, v9
    v_and_b32 v51, s60, v9
    v_cvt_pk_bf16_f32 v9, v52, v53
    v_lshlrev_b32 v52, 16, v9
    v_and_b32 v53, s60, v9
    v_cvt_pk_bf16_f32 v9, v54, v55
    v_lshlrev_b32 v54, 16, v9
    v_and_b32 v55, s60, v9
    v_pk_mul_f32 v[24:25], v[24:25], v[48:49]
    v_pk_mul_f32 v[26:27], v[26:27], v[50:51]
    v_pk_mul_f32 v[28:29], v[28:29], v[52:53]
    v_pk_mul_f32 v[30:31], v[30:31], v[54:55]
    v_cvt_pk_bf16_f32 v9, v24, v25
    v_lshlrev_b32 v24, 16, v9
    v_and_b32 v25, s60, v9
    v_cvt_pk_bf16_f32 v9, v26, v27
    v_lshlrev_b32 v26, 16, v9
    v_and_b32 v27, s60, v9
    v_cvt_pk_bf16_f32 v9, v28, v29
    v_lshlrev_b32 v28, 16, v9
    v_and_b32 v29, s60, v9
    v_cvt_pk_bf16_f32 v9, v30, v31
    v_lshlrev_b32 v30, 16, v9
    v_and_b32 v31, s60, v9
    v_pk_add_f32 v[24:25], v[24:25], v[16:17]
    v_pk_add_f32 v[26:27], v[26:27], v[18:19]
    v_pk_add_f32 v[28:29], v[28:29], v[20:21]
    v_pk_add_f32 v[30:31], v[30:31], v[22:23]
    v_cvt_pk_bf16_f32 v24, v24, v25
    v_cvt_pk_bf16_f32 v25, v26, v27
    v_cvt_pk_bf16_f32 v26, v28, v29
    v_cvt_pk_bf16_f32 v27, v30, v31
    s_mul_i32 s35, s25, 928
    s_add_u32 s35, s35, 118848
    v_lshl_add_u32 v9, v1, 3, s35
    ds_write_b64 v9, v[24:25]
    s_mov_b64 exec, s[44:45]
    ds_write_b64 v9, v[26:27] offset:512
    s_mov_b64 exec, -1
L_s3:
    s_waitcnt lgkmcnt(0)
    s_barrier
    s_lshl_b32 s36, s27, 9
    s_lshl_b32 s33, s3, 6
    s_add_u32 s36, s36, s33
    s_add_u32 s36, s36, 131072
    v_mul_u32_u24 v9, 928, v12
    v_lshl_add_u32 v9, v3, 4, v9
    v_add_u32 v9, 118848, v9
    s_waitcnt lgkmcnt(0)
    ds_read_b128 v[128:131], v9 offset:0
    ds_read_b128 v[132:135], v9 offset:64
    ds_read_b128 v[136:139], v9 offset:128
    ds_read_b128 v[140:143], v9 offset:192
    ds_read_b128 v[144:147], v9 offset:256
    ds_read_b128 v[148:151], v9 offset:320
    ds_read_b128 v[152:155], v9 offset:384
    ds_read_b128 v[156:159], v9 offset:448
    ds_read_b128 v[160:163], v9 offset:512
    ds_read_b128 v[164:167], v9 offset:576
    ds_read_b128 v[168:171], v9 offset:640
    ds_read_b128 v[172:175], v9 offset:704
    ds_read_b128 v[176:179], v9 offset:768
    ds_read_b128 v[180:183], v9 offset:832
    s_waitcnt lgkmcnt(13)
    v_mfma_f32_16x16x32_bf16 v[16:19], v[64:67], v[128:131], 0
    s_waitcnt lgkmcnt(12)
    v_mfma_f32_16x16x32_bf16 v[16:19], v[68:71], v[132:135], v[16:19]
    s_waitcnt lgkmcnt(11)
    v_mfma_f32_16x16x32_bf16 v[16:19], v[72:75], v[136:139], v[16:19]
    s_waitcnt lgkmcnt(10)
    v_mfma_f32_16x16x32_bf16 v[16:19], v[76:79], v[140:143], v[16:19]
    s_waitcnt lgkmcnt(9)
    v_mfma_f32_16x16x32_bf16 v[16:19], v[80:83], v[144:147], v[16:19]
    s_waitcnt lgkmcnt(8)
    v_mfma_f32_16x16x32_bf16 v[16:19], v[84:87], v[148:151], v[16:19]
    s_waitcnt lgkmcnt(7)
    v_mfma_f32_16x16x32_bf16 v[16:19], v[88:91], v[152:155], v[16:19]
    s_waitcnt lgkmcnt(6)
    v_mfma_f32_16x16x32_bf16 v[16:19], v[92:95], v[156:159], v[16:19]
    s_waitcnt lgkmcnt(5)
    v_mfma_f32_16x16x32_bf16 v[16:19], v[96:99], v[160:163], v[16:19]
    s_waitcnt lgkmcnt(4)
    v_mfma_f32_16x16x32_bf16 v[16:19], v[100:103], v[164:167], v[16:19]
    s_waitcnt lgkmcnt(3)
    v_mfma_f32_16x16x32_bf16 v[16:19], v[104:107], v[168:171], v[16:19]
    s_waitcnt lgkmcnt(2)
    v_mfma_f32_16x16x32_bf16 v[16:19], v[108:111], v[172:175], v[16:19]
    s_waitcnt lgkmcnt(1)
    v_mfma_f32_16x16x32_bf16 v[16:19], v[112:115], v[176:179], v[16:19]
    s_waitcnt lgkmcnt(0)
    v_mfma_f32_16x16x32_bf16 v[16:19], v[116:119], v[180:183], v[16:19]
    v_mul_u32_u24 v9, 16384, v12
    v_lshl_add_u32 v9, v3, 4, v9
    v_mov_b32 v22, 0
    v_mov_b32 v23, s28
    s_mov_b32 exec_lo, 0x000f000f
    s_mov_b32 exec_hi, 0x000f000f
    s_nop 1
    v_cvt_pk_bf16_f32 v20, v16, v17
    v_cvt_pk_bf16_f32 v21, v18, v19
    buffer_store_dwordx4 v[20:23], v9, s[12:15], s36 offen sc1
    s_mov_b64 exec, -1
    s_barrier
    s_mov_b32 s16, s72
    s_mov_b32 s17, s73
    s_mov_b32 s18, 3670016
    s_mov_b32 s19, 0x20000
    v_mov_b32 v7, v6
    s_mov_b32 s55, 1024
    s_mul_i32 s56, s3, 7168
    s_mul_i32 s54, s27, 114688
    s_add_u32 s54, s54, s56
    s_mov_b32 m0, s56
    s_add_u32 s56, s56, 1024
    buffer_load_dwordx4 v7, s[16:19], s54 offen nt lds
    s_add_u32 s54, s54, s55
    s_mov_b32 m0, s56
    s_add_u32 s56, s56, 1024
    buffer_load_dwordx4 v7, s[16:19], s54 offen nt lds
    s_add_u32 s54, s54, s55
    s_mov_b32 m0, s56
    s_add_u32 s56, s56, 1024
    buffer_load_dwordx4 v7, s[16:19], s54 offen nt lds
    s_add_u32 s54, s54, s55
    s_mov_b32 m0, s56
    s_add_u32 s56, s56, 1024
    buffer_load_dwordx4 v7, s[16:19], s54 offen nt lds
    s_add_u32 s54, s54, s55
    s_mov_b32 m0, s56
    s_add_u32 s56, s56, 1024
    buffer_load_dwordx4 v7, s[16:19], s54 offen nt lds
    s_add_u32 s54, s54, s55
    s_mov_b32 m0, s56
    s_add_u32 s56, s56, 1024
    buffer_load_dwordx4 v7, s[16:19], s54 offen nt lds
    s_add_u32 s54, s54, s55
    s_mov_b32 m0, s56
    s_add_u32 s56, s56, 1024
    buffer_load_dwordx4 v7, s[16:19], s54 offen nt lds
    s_add_u32 s54, s54, s55
    s_mov_b32 s16, s72
    s_mov_b32 s17, s73
    s_mov_b32 s18, 3670016
    s_mov_b32 s19, 0x20000
    v_mov_b32 v7, v6
    s_mov_b32 s55, 1024
    s_mul_i32 s56, s3, 7168
    s_mul_i32 s54, s27, 114688
    s_add_u32 s54, s54, s56
    s_add_u32 s54, s54, 57344
    s_add_u32 s56, s56, 57360
    s_mov_b32 m0, s56
    s_add_u32 s56, s56, 1024
    buffer_load_dwordx4 v7, s[16:19], s54 offen nt lds
    s_add_u32 s54, s54, s55
    s_mov_b32 m0, s56
    s_add_u32 s56, s56, 1024
    buffer_load_dwordx4 v7, s[16:19], s54 offen nt lds
    s_add_u32 s54, s54, s55
    s_mov_b32 m0, s56
    s_add_u32 s56, s56, 1024
    buffer_load_dwordx4 v7, s[16:19], s54 offen nt lds
    s_add_u32 s54, s54, s55
    s_mov_b32 m0, s56
    s_add_u32 s56, s56, 1024
    buffer_load_dwordx4 v7, s[16:19], s54 offen nt lds
    s_add_u32 s54, s54, s55
    s_mov_b32 m0, s56
    s_add_u32 s56, s56, 1024
    buffer_load_dwordx4 v7, s[16:19], s54 offen nt lds
    s_add_u32 s54, s54, s55
    s_mov_b32 m0, s56
    s_add_u32 s56, s56, 1024
    buffer_load_dwordx4 v7, s[16:19], s54 offen nt lds
    s_add_u32 s54, s54, s55
    s_mov_b32 m0, s56
    s_add_u32 s56, s56, 1024
    buffer_load_dwordx4 v7, s[16:19], s54 offen nt lds
    s_add_u32 s54, s54, s55
    v_mul_u32_u24 v13, 896, v10
    v_lshl_add_u32 v13, v12, 5, v13
    s_lshl_b32 s33, s3, 7
    v_add_u32 v13, s33, v13
    s_waitcnt vmcnt(7)
    s_barrier
    ds_read_b64_tr_b16 v[64:65], v13 offset:0
    ds_read_b64_tr_b16 v[66:67], v13 offset:3584
    ds_read_b64_tr_b16 v[68:69], v13 offset:28672
    ds_read_b64_tr_b16 v[70:71], v13 offset:32256
    ds_read_b64_tr_b16 v[80:81], v13 offset:8
    ds_read_b64_tr_b16 v[82:83], v13 offset:3592
    ds_read_b64_tr_b16 v[84:85], v13 offset:28680
    ds_read_b64_tr_b16 v[86:87], v13 offset:32264
    s_waitcnt lgkmcnt(4)
    ds_read_b64_tr_b16 v[96:97], v13 offset:16
    ds_read_b64_tr_b16 v[98:99], v13 offset:3600
    ds_read_b64_tr_b16 v[100:101], v13 offset:28688
    ds_read_b64_tr_b16 v[102:103], v13 offset:32272
    ds_read_b64_tr_b16 v[112:113], v13 offset:24
    ds_read_b64_tr_b16 v[114:115], v13 offset:3608
    ds_read_b64_tr_b16 v[116:117], v13 offset:28696
    ds_read_b64_tr_b16 v[118:119], v13 offset:32280
    s_waitcnt lgkmcnt(4)
    s_waitcnt lgkmcnt(0)
    s_barrier
    s_cmp_lt_u32 s27, 28
    s_cbranch_scc1 L_j3
    s_waitcnt vmcnt(0)
    s_branch L_j3b
L_j3:
    s_mov_b32 s16, s80
    s_mov_b32 s17, s81
    s_mov_b32 s18, 1605632
    s_mov_b32 s19, 0x20000
    v_mov_b32 v7, v6
    s_mov_b32 s55, 1024
    s_mul_i32 s56, s3, 7168
    s_mul_i32 s54, s27, 57344
    s_add_u32 s54, s54, s56
    s_mov_b32 m0, s56
    s_add_u32 s56, s56, 1024
    buffer_load_dwordx4 v7, s[16:19], s54 offen nt lds
    s_add_u32 s54, s54, s55
    s_mov_b32 m0, s56
    s_add_u32 s56, s56, 1024
    buffer_load_dwordx4 v7, s[16:19], s54 offen nt lds
    s_add_u32 s54, s54, s55
    s_mov_b32 m0, s56
    s_add_u32 s56, s56, 1024
    buffer_load_dwordx4 v7, s[16:19], s54 offen nt lds
    s_add_u32 s54, s54, s55
    s_mov_b32 m0, s56
    s_add_u32 s56, s56, 1024
    buffer_load_dwordx4 v7, s[16:19], s54 offen nt lds
    s_add_u32 s54, s54, s55
    s_mov_b32 m0, s56
    s_add_u32 s56, s56, 1024
    buffer_load_dwordx4 v7, s[16:19], s54 offen nt lds
    s_add_u32 s54, s54, s55
    s_mov_b32 m0, s56
    s_add_u32 s56, s56, 1024
    buffer_load_dwordx4 v7, s[16:19], s54 offen nt lds
    s_add_u32 s54, s54, s55
    s_mov_b32 m0, s56
    s_add_u32 s56, s56, 1024
    buffer_load_dwordx4 v7, s[16:19], s54 offen nt lds
    s_add_u32 s54, s54, s55
    s_waitcnt vmcnt(7)
L_j3b:
    s_barrier
    v_add_u32 v13, 57360, v13
    ds_read_b64_tr_b16 v[72:73], v13 offset:0
    ds_read_b64_tr_b16 v[74:75], v13 offset:3584
    ds_read_b64_tr_b16 v[76:77], v13 offset:28672
    ds_read_b64_tr_b16 v[78:79], v13 offset:32256
    ds_read_b64_tr_b16 v[88:89], v13 offset:8
    ds_read_b64_tr_b16 v[90:91], v13 offset:3592
    ds_read_b64_tr_b16 v[92:93], v13 offset:28680
    ds_read_b64_tr_b16 v[94:95], v13 offset:32264
    s_waitcnt lgkmcnt(4)
    ds_read_b64_tr_b16 v[104:105], v13 offset:16
    ds_read_b64_tr_b16 v[106:107], v13 offset:3600
    ds_read_b64_tr_b16 v[108:109], v13 offset:28688
    ds_read_b64_tr_b16 v[110:111], v13 offset:32272
    ds_read_b64_tr_b16 v[120:121], v13 offset:24
    ds_read_b64_tr_b16 v[122:123], v13 offset:3608
    ds_read_b64_tr_b16 v[124:125], v13 offset:28696
    ds_read_b64_tr_b16 v[126:127], v13 offset:32280
    s_waitcnt lgkmcnt(4)
    s_cmp_lt_u32 s27, 28
    s_cbranch_scc0 L_p5
    s_waitcnt lgkmcnt(0)
    s_barrier
    s_mov_b32 s16, s78
    s_mov_b32 s17, s79
    s_mov_b32 s18, 1605632
    s_mov_b32 s19, 0x20000
    s_mov_b32 s33, 3584
    v_mad_u32_u24 v7, v4, s33, v5
    s_mov_b32 s55, 28672
    s_mul_i32 s54, s3, 200704
    s_lshl_b32 s33, s27, 7
    s_add_u32 s54, s54, s33
    s_mul_i32 s56, s3, 7168
    s_add_u32 s56, s56, 57360
    s_mov_b32 m0, s56
    s_add_u32 s56, s56, 1024
    buffer_load_dwordx4 v7, s[16:19], s54 offen nt lds
    s_add_u32 s54, s54, s55
    v_xor_b32 v7, 64, v7
    s_mov_b32 m0, s56
    s_add_u32 s56, s56, 1024
    buffer_load_dwordx4 v7, s[16:19], s54 offen nt lds
    s_add_u32 s54, s54, s55
    v_xor_b32 v7, 64, v7
    s_mov_b32 m0, s56
    s_add_u32 s56, s56, 1024
    buffer_load_dwordx4 v7, s[16:19], s54 offen nt lds
    s_add_u32 s54, s54, s55
    v_xor_b32 v7, 64, v7
    s_mov_b32 m0, s56
    s_add_u32 s56, s56, 1024
    buffer_load_dwordx4 v7, s[16:19], s54 offen nt lds
    s_add_u32 s54, s54, s55
    v_xor_b32 v7, 64, v7
    s_mov_b32 m0, s56
    s_add_u32 s56, s56, 1024
    buffer_load_dwordx4 v7, s[16:19], s54 offen nt lds
    s_add_u32 s54, s54, s55
    v_xor_b32 v7, 64, v7
    s_mov_b32 m0, s56
    s_add_u32 s56, s56, 1024
    buffer_load_dwordx4 v7, s[16:19], s54 offen nt lds
    s_add_u32 s54, s54, s55
    v_xor_b32 v7, 64, v7
    s_mov_b32 m0, s56
    s_add_u32 s56, s56, 1024
    buffer_load_dwordx4 v7, s[16:19], s54 offen nt lds
    s_add_u32 s54, s54, s55
    v_xor_b32 v7, 64, v7
    s_waitcnt vmcnt(7)
    s_barrier
    v_subrev_u32 v13, 57360, v13
    ds_read_b64_tr_b16 v[184:185], v13 offset:0
    ds_read_b64_tr_b16 v[186:187], v13 offset:3584
    ds_read_b64_tr_b16 v[188:189], v13 offset:28672
    ds_read_b64_tr_b16 v[190:191], v13 offset:32256
    ds_read_b64_tr_b16 v[192:193], v13 offset:8
    ds_read_b64_tr_b16 v[194:195], v13 offset:3592
    ds_read_b64_tr_b16 v[196:197], v13 offset:28680
    ds_read_b64_tr_b16 v[198:199], v13 offset:32264
    s_waitcnt lgkmcnt(4)
    ds_read_b64_tr_b16 v[200:201], v13 offset:16
    ds_read_b64_tr_b16 v[202:203], v13 offset:3600
    ds_read_b64_tr_b16 v[204:205], v13 offset:28688
    ds_read_b64_tr_b16 v[206:207], v13 offset:32272
    ds_read_b64_tr_b16 v[208:209], v13 offset:24
    ds_read_b64_tr_b16 v[210:211], v13 offset:3608
    ds_read_b64_tr_b16 v[212:213], v13 offset:28696
    ds_read_b64_tr_b16 v[214:215], v13 offset:32280
    s_waitcnt lgkmcnt(4)
    s_waitcnt lgkmcnt(0)
    s_barrier
    s_mov_b32 s16, s76
    s_mov_b32 s17, s77
    s_mov_b32 s18, 1605632
    s_mov_b32 s19, 0x20000
    s_mov_b32 s33, 3584
    v_mad_u32_u24 v7, v4, s33, v5
    s_mov_b32 s55, 28672
    s_mul_i32 s54, s3, 200704
    s_lshl_b32 s33, s27, 7
    s_add_u32 s54, s54, s33
    s_mul_i32 s56, s3, 7168
    s_mov_b32 m0, s56
    s_add_u32 s56, s56, 1024
    buffer_load_dwordx4 v7, s[16:19], s54 offen nt lds
    s_add_u32 s54, s54, s55
    v_xor_b32 v7, 64, v7
    s_mov_b32 m0, s56
    s_add_u32 s56, s56, 1024
    buffer_load_dwordx4 v7, s[16:19], s54 offen nt lds
    s_add_u32 s54, s54, s55
    v_xor_b32 v7, 64, v7
    s_mov_b32 m0, s56
    s_add_u32 s56, s56, 1024
    buffer_load_dwordx4 v7, s[16:19], s54 offen nt lds
    s_add_u32 s54, s54, s55
    v_xor_b32 v7, 64, v7
    s_mov_b32 m0, s56
    s_add_u32 s56, s56, 1024
    buffer_load_dwordx4 v7, s[16:19], s54 offen nt lds
    s_add_u32 s54, s54, s55
    v_xor_b32 v7, 64, v7
    s_mov_b32 m0, s56
    s_add_u32 s56, s56, 1024
    buffer_load_dwordx4 v7, s[16:19], s54 offen nt lds
    s_add_u32 s54, s54, s55
    v_xor_b32 v7, 64, v7
    s_mov_b32 m0, s56
    s_add_u32 s56, s56, 1024
    buffer_load_dwordx4 v7, s[16:19], s54 offen nt lds
    s_add_u32 s54, s54, s55
    v_xor_b32 v7, 64, v7
    s_mov_b32 m0, s56
    s_add_u32 s56, s56, 1024
    buffer_load_dwordx4 v7, s[16:19], s54 offen nt lds
    s_add_u32 s54, s54, s55
    v_xor_b32 v7, 64, v7
    s_waitcnt vmcnt(0)
    s_barrier
    v_lshlrev_b32 v13, 7, v10
    v_bfe_u32 v9, v1, 3, 2
    v_lshlrev_b32 v9, 1, v9
    v_xor_b32 v9, s3, v9
    v_lshl_add_u32 v13, v9, 4, v13
    v_and_b32 v9, 1, v1
    v_lshl_add_u32 v13, v9, 3, v13
    v_bfe_u32 v9, v1, 1, 1
    v_mul_u32_u24 v9, 57360, v9
    v_add_u32 v13, v13, v9
    ds_read_b64_tr_b16 v[128:129], v13 offset:0
    ds_read_b64_tr_b16 v[130:131], v13 offset:512
    ds_read_b64_tr_b16 v[132:133], v13 offset:4096
    ds_read_b64_tr_b16 v[134:135], v13 offset:4608
    ds_read_b64_tr_b16 v[136:137], v13 offset:8192
    ds_read_b64_tr_b16 v[138:139], v13 offset:8704
    ds_read_b64_tr_b16 v[140:141], v13 offset:12288
    ds_read_b64_tr_b16 v[142:143], v13 offset:12800
    s_waitcnt lgkmcnt(6)
    ds_read_b64_tr_b16 v[144:145], v13 offset:16384
    ds_read_b64_tr_b16 v[146:147], v13 offset:16896
    ds_read_b64_tr_b16 v[148:149], v13 offset:20480
    ds_read_b64_tr_b16 v[150:151], v13 offset:20992
    ds_read_b64_tr_b16 v[152:153], v13 offset:24576
    ds_read_b64_tr_b16 v[154:155], v13 offset:25088
    ds_read_b64_tr_b16 v[156:157], v13 offset:28672
    ds_read_b64_tr_b16 v[158:159], v13 offset:29184
    s_waitcnt lgkmcnt(6)
    ds_read_b64_tr_b16 v[160:161], v13 offset:32768
    ds_read_b64_tr_b16 v[162:163], v13 offset:33280
    ds_read_b64_tr_b16 v[164:165], v13 offset:36864
    ds_read_b64_tr_b16 v[166:167], v13 offset:37376
    ds_read_b64_tr_b16 v[168:169], v13 offset:40960
    ds_read_b64_tr_b16 v[170:171], v13 offset:41472
    ds_read_b64_tr_b16 v[172:173], v13 offset:45056
    ds_read_b64_tr_b16 v[174:175], v13 offset:45568
    s_waitcnt lgkmcnt(6)
    ds_read_b64_tr_b16 v[176:177], v13 offset:49152
    ds_read_b64_tr_b16 v[178:179], v13 offset:49664
    ds_read_b64_tr_b16 v[180:181], v13 offset:53248
    ds_read_b64_tr_b16 v[182:183], v13 offset:53760
    s_cmp_lt_u32 s3, 4
    s_cselect_b64 s[74:75], -1, s[44:45]
    s_cselect_b64 s[52:53], 0, -1
    v_cndmask_b32 v13, v6, v15, s[52:53]
    s_mul_i32 s61, s25, 10752
    s_add_u32 s61, s61, 28160
    v_and_b32 v9, 1, v3
    v_lshrrev_b32 v239, 1, v3
    v_lshl_add_u32 v239, v9, 1, v239
    v_lshl_add_u32 v255, v239, 2, v12
    v_lshlrev_b32 v255, 1, v255
    v_lshlrev_b32 v239, 4, v239
    s_lshl_b32 s33, s27, 6
    v_add_u32 v7, s33, v239
    s_add_u32 s34, s61, 5376
    s_mul_i32 s62, s25, 896
    s_lshl_b32 s33, s27, 5
    s_add_u32 s62, s62, s33
    s_mov_b32 s20, s64
    s_mov_b32 s21, s65
    s_mov_b32 s22, 3584
    s_mov_b32 s23, 0x20000
    buffer_load_ushort v250, v255, s[20:23], s62 offen
L_mpoll:
    buffer_load_dwordx4 v[16:19], v13, s[12:15], s61 offen offset:1792 sc1
    buffer_load_dwordx4 v[20:23], v13, s[12:15], s61 offen offset:3584 sc1
    buffer_load_dwordx4 v[24:27], v7, s[12:15], s61 offen sc1
    buffer_load_dwordx4 v[28:31], v7, s[12:15], s34 offen sc1
    s_waitcnt vmcnt(0)
    v_xor_b32 v9, s28, v19
    v_bitop3_b32 v9, v9, v23, s28 bitop3:0xf6
    v_cndmask_b32 v9, 0, v9, s[74:75]
    v_bitop3_b32 v9, v9, v27, s28 bitop3:0xf6
    v_bitop3_b32 v9, v9, v31, s28 bitop3:0xf6
    v_cmp_ne_u32 vcc, 0, v9
    s_cbranch_vccz L_ok_4
    s_sub_u32 s29, s29, 1
    s_cbranch_scc0 L_mpoll
    s_mov_b32 s29, 0
L_ok_4:
    v_lshlrev_b32 v244, 16, v16
    v_and_b32 v245, s60, v16
    v_lshlrev_b32 v240, 16, v20
    v_and_b32 v241, s60, v20
    v_lshlrev_b32 v246, 16, v17
    v_and_b32 v247, s60, v17
    v_lshlrev_b32 v242, 16, v21
    v_and_b32 v243, s60, v21
    v_add_f32 v240, 1.0, v240
    v_add_f32 v241, 1.0, v241
    v_add_f32 v242, 1.0, v242
    v_add_f32 v243, 1.0, v243
    v_cvt_pk_bf16_f32 v9, v240, v241
    v_lshlrev_b32 v240, 16, v9
    v_and_b32 v241, s60, v9
    v_cvt_pk_bf16_f32 v9, v242, v243
    v_lshlrev_b32 v242, 16, v9
    v_and_b32 v243, s60, v9
    s_mov_b32 vcc_lo, 0xcccccccc
    s_mov_b32 vcc_hi, 0xcccccccc
    v_cndmask_b32 v248, v24, v25, vcc
    v_cndmask_b32 v249, v28, v29, vcc
    v_and_b32 v9, 1, v1
    v_lshlrev_b32 v9, 4, v9
    v_lshrrev_b32 v248, v9, v248
    v_lshrrev_b32 v249, v9, v249
    v_lshlrev_b32 v248, 16, v248
    v_lshlrev_b32 v249, 16, v249
    v_lshlrev_b32 v250, 16, v250
    s_mul_i32 s33, s25, 960
    s_lshr_b32 s35, s3, 2
    s_lshl_b32 s35, s35, 8
    s_add_u32 s33, s33, s35
    s_add_u32 s33, s33, 118848
    v_lshl_add_u32 v251, v1, 2, s33
    v_bfe_u32 v9, v1, 1, 1
    v_lshl_add_u32 v9, v3, 1, v9
    v_mul_u32_u24 v253, 96, v9
    v_and_b32 v9, 12, v2
    v_add_u32 v253, v253, v9
    v_and_b32 v9, 1, v1
    v_lshl_add_u32 v253, v9, 1, v253
    s_lshl_b32 s33, s3, 3
    s_add_u32 s33, s33, 123968
    v_add_u32 v253, s33, v253
    s_mul_i32 s61, s25, 1792
    s_add_u32 s61, s61, 16384
    s_mul_i32 s69, s25, 28
    s_add_u32 s69, s69, s27
    s_mul_i32 s69, s69, 2048
    s_add_u32 s69, s69, 1245184
    buffer_load_dwordx4 v[16:19], v6, s[12:15], s69 offen offset:0 sc1
    buffer_load_dwordx4 v[16:19], v6, s[12:15], s69 offen offset:1024 sc1
    buffer_load_dwordx4 v[16:19], v6, s[12:15], s61 offen sc1
    buffer_load_dwordx4 v[16:19], v15, s[12:15], s61 offen sc1
L_p5:
    v_and_b32 v13, 0x1f0, v6
    s_mov_b32 s34, 4096
L_xpoll:
    buffer_load_dwordx4 v[16:19], v13, s[12:15], s34 offen sc1
    s_waitcnt vmcnt(0)
    v_cmp_ne_u32 vcc, s28, v19
    s_cbranch_vccz L_ok_5
    s_sub_u32 s29, s29, 1
    s_cbranch_scc0 L_xpoll
    s_mov_b32 s29, 0
L_ok_5:
    s_getreg_b32 s33, hwreg(HW_REG_XCC_ID)
    v_cmp_ne_u32 vcc, s33, v16
    s_cmp_eq_u64 vcc, 0
    s_cselect_b32 s31, 1, 0
    v_lshrrev_b32 v9, 2, v2
    v_mul_u32_u24 v4, 28, v3
    v_add_u32 v4, v4, v9
    v_mul_u32_u24 v4, 2048, v4
    v_lshl_add_u32 v4, v12, 4, v4
    s_mul_i32 s67, s3, 8192
    s_lshl_b32 s33, s27, 6
    s_add_u32 s67, s67, s33
    s_add_u32 s67, s67, 1245184
    v_and_b32 v13, 1, v1
    v_lshl_add_u32 v9, v9, 1, v13
    v_lshlrev_b32 v10, 4, v3
    v_mul_u32_u24 v7, 160, v9
    v_add_u32 v7, v7, v10
    v_add_u32 v7, 122688, v7
    v_mul_u32_u24 v252, 480, v9
    v_add_u32 v252, v252, v10
    v_add_u32 v252, 118848, v252
    v_mul_u32_u24 v254, 96, v9
    v_add_u32 v254, v254, v10
    v_add_u32 v254, 123968, v254
    v_mul_u32_u24 v238, 0xaaaa, v13
    v_add_u32 v238, 0x4444, v238
    s_mul_i32 s33, s25, 320
    s_lshr_b32 s35, s3, 2
    s_lshl_b32 s34, s35, 6
    s_add_u32 s33, s33, s34
    s_add_u32 s33, s33, 122688
    v_mul_u32_u24 v5, 160, v13
    v_bfe_u32 v9, v1, 1, 4
    v_lshl_add_u32 v5, v9, 2, v5
    v_add_u32 v5, s33, v5
    v_mov_b32 v216, 0
    v_mov_b32 v217, 0
    v_mov_b32 v218, 0
    v_mov_b32 v219, 0
    v_mov_b32 v220, 0
    v_mov_b32 v221, 0
    v_mov_b32 v222, 0
    v_mov_b32 v223, 0
    v_mov_b32 v224, 0
    v_mov_b32 v225, 0
    v_mov_b32 v226, 0
    v_mov_b32 v227, 0
    v_mov_b32 v228, 0
    v_mov_b32 v229, 0
    v_mov_b32 v230, 0
    v_mov_b32 v231, 0
    v_mov_b32 v232, 0
    v_mov_b32 v233, 0
    v_mov_b32 v234, 0
    v_mov_b32 v235, 0
    s_lshl_b32 s68, s25, 18
    s_lshl_b32 s34, s27, 13
    s_add_u32 s68, s68, s34
    s_lshl_b32 s34, s35, 12
    s_add_u32 s68, s68, s34
    s_add_u32 s68, s68, 196608
    v_mov_b32 v28, 0
    v_mov_b32 v29, 0
    v_mov_b32 v30, 0xff7fffff
    v_mov_b32 v31, s28
    s_waitcnt lgkmcnt(0)
    s_mov_b64 s[4:5], -1
    s_mov_b64 s[6:7], -1
    s_mov_b64 s[8:9], -1
    s_mov_b64 s[10:11], -1
    s_mov_b32 s11, 0
L_opoll:
    s_mov_b64 exec, s[4:5]
    s_cbranch_execz L_os0
    buffer_load_dwordx4 v[16:19], v6, s[12:15], s68 offen offset:0 sc1
L_os0:
    s_mov_b64 exec, s[6:7]
    s_cbranch_execz L_os1
    buffer_load_dwordx4 v[20:23], v6, s[12:15], s68 offen offset:1024 sc1
L_os1:
    s_mov_b64 exec, s[8:9]
    s_cbranch_execz L_os2
    buffer_load_dwordx4 v[24:27], v6, s[12:15], s68 offen offset:2048 sc1
L_os2:
    s_mov_b64 exec, s[10:11]
    s_cbranch_execz L_os3
    buffer_load_dwordx4 v[28:31], v6, s[12:15], s68 offen offset:3072 sc1
L_os3:
    s_mov_b64 exec, -1
    s_waitcnt vmcnt(0)
    v_cmp_ne_u32 s[4:5], s28, v19
    v_cmp_ne_u32 s[6:7], s28, v23
    v_cmp_ne_u32 s[8:9], s28, v27
    v_cmp_ne_u32 s[10:11], s28, v31
    s_or_b64 vcc, s[4:5], s[6:7]
    s_or_b64 vcc, vcc, s[8:9]
    s_or_b64 vcc, vcc, s[10:11]
    s_cbranch_vccz L_ok_6
    s_sub_u32 s29, s29, 1
    s_cbranch_scc0 L_opoll
    s_mov_b32 s29, 0
L_ok_6:
    v_max3_f32 v32, v18, v22, v26
    v_max_f32 v32, v32, v30
    v_mov_b32 v33, v32
    s_nop 1
    v_permlane32_swap_b32 v32, v33
    v_max_f32 v32, v32, v33
    v_sub_f32 v18, v18, v32
    v_sub_f32 v22, v22, v32
    v_sub_f32 v26, v26, v32
    v_sub_f32 v30, v30, v32
    v_exp_f32 v18, v18
    v_exp_f32 v22, v22
    v_exp_f32 v26, v26
    v_exp_f32 v30, v30
    v_pk_mul_f32 v[34:35], v[16:17], v[18:19] op_sel_hi:[1,0]
    v_add_f32 v36, v18, v22
    v_pk_fma_f32 v[34:35], v[20:21], v[22:23], v[34:35] op_sel_hi:[1,0,1]
    v_pk_fma_f32 v[34:35], v[24:25], v[26:27], v[34:35] op_sel_hi:[1,0,1]
    v_pk_fma_f32 v[34:35], v[28:29], v[30:31], v[34:35] op_sel_hi:[1,0,1]
    v_add_f32 v37, v26, v30
    v_add_f32 v36, v36, v37
    v_mov_b32 v38, v34
    v_mov_b32 v39, v35
    v_mov_b32 v37, v36
    s_nop 0
    v_permlane32_swap_b32 v34, v38
    v_permlane32_swap_b32 v35, v39
    v_permlane32_swap_b32 v36, v37
    v_pk_add_f32 v[34:35], v[34:35], v[38:39]
    v_add_f32 v36, v36, v37
    v_rcp_f32 v36, v36
    s_nop 0
    v_pk_mul_f32 v[34:35], v[34:35], v[36:37] op_sel_hi:[1,0]
    v_cvt_pk_bf16_f32 v34, v34, v35
    ds_write_b32 v5, v34
    s_waitcnt lgkmcnt(0)
    s_barrier
    s_cmp_eq_u32 s3, 7
    s_cbranch_scc1 L_t2
    ds_read_b128 v[48:51], v7 offset:0
    ds_read_b128 v[52:55], v7 offset:64
    s_waitcnt lgkmcnt(1)
    v_smfmac_f32_16x16x64_bf16 v[216:219], v[48:51], v[64:71], v238
    v_smfmac_f32_16x16x64_bf16 v[220:223], v[48:51], v[80:87], v238
    v_smfmac_f32_16x16x64_bf16 v[224:227], v[48:51], v[96:103], v238
    v_smfmac_f32_16x16x64_bf16 v[228:231], v[48:51], v[112:119], v238
    s_waitcnt lgkmcnt(0)
    v_smfmac_f32_16x16x64_bf16 v[216:219], v[52:55], v[72:79], v238
    v_smfmac_f32_16x16x64_bf16 v[220:223], v[52:55], v[88:95], v238
    v_smfmac_f32_16x16x64_bf16 v[224:227], v[52:55], v[104:111], v238
    v_smfmac_f32_16x16x64_bf16 v[228:231], v[52:55], v[120:127], v238
    s_nop 4
    v_add_f32 v40, v216, v217
    v_add_f32 v41, v220, v221
    v_add_f32 v42, v224, v225
    v_add_f32 v43, v228, v229
    v_and_b32 v40, -2, v40
    v_and_b32 v41, -2, v41
    v_and_b32 v42, -2, v42
    v_and_b32 v43, -2, v43
    s_cmp_eq_u32 s31, 0
    s_cbranch_scc1 L_xs1
    buffer_store_dwordx4 v[40:43], v4, s[12:15], s67 offen
    s_branch L_xd1
L_xs1:
    buffer_store_dwordx4 v[40:43], v4, s[12:15], s67 offen sc1
L_xd1:
    v_mov_b32 v216, 0
    v_mov_b32 v217, 0
    v_mov_b32 v220, 0
    v_mov_b32 v221, 0
    v_mov_b32 v224, 0
    v_mov_b32 v225, 0
    v_mov_b32 v228, 0
    v_mov_b32 v229, 0
L_t2:
    s_cmp_lt_u32 s27, 28
    s_cbranch_scc0 L_fin
    s_cmp_lt_u32 s3, 4
    s_cbranch_scc1 L_x1b
    v_mov_b32 v47, s28
    v_mov_b32 v46, 0
    s_lshl_b32 s35, s62, 1
    s_add_u32 s35, s35, 16384
L_ypoll:
    buffer_load_dwordx4 v[24:27], v6, s[12:15], s69 offen sc1
    buffer_load_dwordx4 v[20:23], v6, s[12:15], s69 offen offset:1024 sc1
    s_waitcnt vmcnt(0)
    v_bitop3_b32 v9, v24, v25, v26 bitop3:0xfe
    v_bitop3_b32 v10, v27, v20, v21 bitop3:0xfe
    v_bitop3_b32 v9, v9, v22, v23 bitop3:0xfe
    v_bitop3_b32 v9, v9, v10, 1 bitop3:0xa8
    v_cmp_ne_u32 vcc, 0, v9
    v_pk_add_f32 v[16:17], v[24:25], v[20:21]
    v_pk_add_f32 v[18:19], v[26:27], v[22:23]
    s_cbranch_vccz L_ok_7
    s_sub_u32 s29, s29, 1
    s_cbranch_scc0 L_ypoll
    s_mov_b32 s29, 0
L_ok_7:
    s_nop 0
    v_permlane32_swap_b32 v16, v17
    v_permlane32_swap_b32 v18, v19
    v_add_f32 v16, v16, v17
    v_add_f32 v18, v18, v19
    s_nop 1
    v_permlane16_swap_b32 v16, v18
    v_add_f32 v16, v16, v18
    s_nop 1
    v_add_f32 v16, v16, v16 row_ror:4 row_mask:0xf bank_mask:0xf
    s_nop 1
    v_add_f32 v16, v16, v16 row_ror:8 row_mask:0xf bank_mask:0xf
    v_cvt_pk_bf16_f32 v16, v16, v16
    v_lshlrev_b32 v16, 16, v16
    v_mul_f32 v16, v16, v248
    v_cvt_pk_bf16_f32 v16, v16, v16
    v_lshlrev_b32 v16, 16, v16
    v_add_f32 v250, v250, v16
    s_nop 1
    v_mov_b32 v17, v250 quad_perm:[1,1,3,3] row_mask:0xf bank_mask:0xf
    v_cvt_pk_bf16_f32 v44, v250, v17
    s_nop 1
    v_mov_b32 v45, v44 quad_perm:[2,2,2,2] row_mask:0xf bank_mask:0xf
    s_mov_b32 exec_lo, 0x00010001
    s_mov_b32 exec_hi, 0x00010001
    s_cmp_eq_u32 s31, 0
    s_cbranch_scc1 L_xs2
    buffer_store_dwordx4 v[44:47], v239, s[12:15], s35 offen
    s_branch L_xd2
L_xs2:
    buffer_store_dwordx4 v[44:47], v239, s[12:15], s35 offen sc1
L_xd2:
    s_mov_b64 exec, -1
    v_cvt_pk_bf16_f32 v250, v250, v250
    v_lshlrev_b32 v250, 16, v250
L_x1b:
    s_barrier
L_x1poll:
    buffer_load_dwordx4 v[16:19], v6, s[12:15], s61 offen sc1
    buffer_load_dwordx4 v[20:23], v15, s[12:15], s61 offen sc1
    s_waitcnt vmcnt(0)
    v_xor_b32 v9, s28, v23
    v_cndmask_b32 v9, 0, v9, s[44:45]
    v_bitop3_b32 v9, v9, v19, s28 bitop3:0xf6
    v_cmp_ne_u32 vcc, 0, v9
    s_cbranch_vccz L_ok_8
    s_sub_u32 s29, s29, 1
    s_cbranch_scc0 L_x1poll
    s_mov_b32 s29, 0
L_ok_8:
    v_lshlrev_b32 v24, 16, v16
    v_and_b32 v25, s60, v16
    v_lshlrev_b32 v26, 16, v17
    v_and_b32 v27, s60, v17
    v_lshlrev_b32 v28, 16, v20
    v_and_b32 v29, s60, v20
    v_lshlrev_b32 v30, 16, v21
    v_and_b32 v31, s60, v21
    v_pk_add_f32 v[32:33], v[24:25], v[26:27]
    v_pk_add_f32 v[34:35], v[28:29], v[30:31]
    v_pk_add_f32 v[32:33], v[32:33], v[34:35]
    v_add_f32 v32, v32, v33
    v_cndmask_b32 v44, v24, v28, s[52:53]
    v_cndmask_b32 v45, v25, v29, s[52:53]
    v_add_f32 v32, v32, v32 quad_perm:[1,0,3,2] row_mask:0xf bank_mask:0xf
    v_cndmask_b32 v46, v26, v30, s[52:53]
    v_cndmask_b32 v47, v27, v31, s[52:53]
    v_add_f32 v32, v32, v32 quad_perm:[2,3,0,1] row_mask:0xf bank_mask:0xf
    s_nop 1
    v_add_f32 v32, v32, v32 row_half_mirror row_mask:0xf bank_mask:0xf
    s_nop 1
    v_add_f32 v32, v32, v32 row_mirror row_mask:0xf bank_mask:0xf
    s_nop 1
    v_add_f32 v32, v32, v32 row_bcast:15 row_mask:0xa bank_mask:0xf
    s_nop 1
    v_add_f32 v32, v32, v32 row_bcast:31 row_mask:0xc bank_mask:0xf
    s_nop 0
    v_readlane_b32 s37, v32, 63
    s_nop 1
    v_mov_b32 v40, 0x3b124925
    v_mul_f32 v32, s37, v40
    v_pk_add_f32 v[34:35], v[24:25], v[32:33] op_sel_hi:[1,0] neg_lo:[0,1] neg_hi:[0,1]
    v_pk_add_f32 v[36:37], v[26:27], v[32:33] op_sel_hi:[1,0] neg_lo:[0,1] neg_hi:[0,1]
    v_pk_mul_f32 v[38:39], v[34:35], v[34:35]
    v_pk_add_f32 v[34:35], v[28:29], v[32:33] op_sel_hi:[1,0] neg_lo:[0,1] neg_hi:[0,1]
    v_pk_fma_f32 v[38:39], v[36:37], v[36:37], v[38:39]
    v_pk_add_f32 v[36:37], v[30:31], v[32:33] op_sel_hi:[1,0] neg_lo:[0,1] neg_hi:[0,1]
    s_mov_b64 exec, s[44:45]
    v_pk_fma_f32 v[38:39], v[34:35], v[34:35], v[38:39]
    v_pk_fma_f32 v[38:39], v[36:37], v[36:37], v[38:39]
    s_mov_b64 exec, -1
    v_add_f32 v38, v38, v39
    v_cvt_pk_bf16_f32 v32, v32, v32
    v_lshlrev_b32 v32, 16, v32
    v_add_f32 v38, v38, v38 quad_perm:[1,0,3,2] row_mask:0xf bank_mask:0xf
    v_pk_add_f32 v[44:45], v[44:45], v[32:33] op_sel_hi:[1,0] neg_lo:[0,1] neg_hi:[0,1]
    v_pk_add_f32 v[46:47], v[46:47], v[32:33] op_sel_hi:[1,0] neg_lo:[0,1] neg_hi:[0,1]
    v_add_f32 v38, v38, v38 quad_perm:[2,3,0,1] row_mask:0xf bank_mask:0xf
    v_cvt_pk_bf16_f32 v34, v44, v45
    v_lshlrev_b32 v44, 16, v34
    v_add_f32 v38, v38, v38 row_half_mirror row_mask:0xf bank_mask:0xf
    v_and_b32 v45, s60, v34
    v_cvt_pk_bf16_f32 v34, v46, v47
    v_add_f32 v38, v38, v38 row_mirror row_mask:0xf bank_mask:0xf
    v_lshlrev_b32 v46, 16, v34
    v_and_b32 v47, s60, v34
    v_add_f32 v38, v38, v38 row_bcast:15 row_mask:0xa bank_mask:0xf
    s_nop 1
    v_add_f32 v38, v38, v38 row_bcast:31 row_mask:0xc bank_mask:0xf
    s_nop 0
    v_readlane_b32 s37, v38, 63
    s_nop 1
    v_mul_f32 v38, s37, v40
    v_cvt_pk_bf16_f32 v38, v38, v38
    v_lshlrev_b32 v38, 16, v38
    v_add_f32 v38, 0x3727c5ac, v38
    v_cvt_pk_bf16_f32 v38, v38, v38
    v_lshlrev_b32 v38, 16, v38
    v_sqrt_f32 v38, v38
    s_nop 0
    v_cvt_pk_bf16_f32 v38, v38, v38
    v_lshlrev_b32 v38, 16, v38
    v_rcp_f32 v38, v38
    s_nop 0
    v_pk_mul_f32 v[44:45], v[44:45], v[38:39] op_sel_hi:[1,0]
    v_pk_mul_f32 v[46:47], v[46:47], v[38:39] op_sel_hi:[1,0]
    v_cvt_pk_bf16_f32 v9, v44, v45
    v_lshlrev_b32 v44, 16, v9
    v_and_b32 v45, s60, v9
    v_cvt_pk_bf16_f32 v9, v46, v47
    v_lshlrev_b32 v46, 16, v9
    v_and_b32 v47, s60, v9
    v_pk_mul_f32 v[44:45], v[44:45], v[240:241]
    v_pk_mul_f32 v[46:47], v[46:47], v[242:243]
    v_cvt_pk_bf16_f32 v9, v44, v45
    v_lshlrev_b32 v44, 16, v9
    v_and_b32 v45, s60, v9
    v_cvt_pk_bf16_f32 v9, v46, v47
    v_lshlrev_b32 v46, 16, v9
    v_and_b32 v47, s60, v9
    v_pk_add_f32 v[44:45], v[44:45], v[244:245]
    v_pk_add_f32 v[46:47], v[46:47], v[246:247]
    v_cvt_pk_bf16_f32 v44, v44, v45
    v_cvt_pk_bf16_f32 v45, v46, v47
    s_mov_b64 exec, s[74:75]
    ds_write2_b32 v251, v44, v45 offset0:0 offset1:120
    s_mov_b64 exec, -1
    s_waitcnt lgkmcnt(0)
    s_barrier
    ds_read_b128 v[64:67], v252 offset:0
    ds_read_b128 v[68:71], v252 offset:64
    ds_read_b128 v[72:75], v252 offset:128
    ds_read_b128 v[76:79], v252 offset:192
    ds_read_b128 v[80:83], v252 offset:256
    ds_read_b128 v[84:87], v252 offset:320
    ds_read_b128 v[88:91], v252 offset:384
    s_waitcnt lgkmcnt(6)
    v_smfmac_f32_16x16x64_bf16 v[232:235], v[64:67], v[128:135], v238
    s_waitcnt lgkmcnt(5)
    v_smfmac_f32_16x16x64_bf16 v[232:235], v[68:71], v[136:143], v238
    s_waitcnt lgkmcnt(4)
    v_smfmac_f32_16x16x64_bf16 v[232:235], v[72:75], v[144:151], v238
    s_waitcnt lgkmcnt(3)
    v_smfmac_f32_16x16x64_bf16 v[232:235], v[76:79], v[152:159], v238
    s_waitcnt lgkmcnt(2)
    v_smfmac_f32_16x16x64_bf16 v[232:235], v[80:83], v[160:167], v238
    s_waitcnt lgkmcnt(1)
    v_smfmac_f32_16x16x64_bf16 v[232:235], v[84:87], v[168:175], v238
    s_waitcnt lgkmcnt(0)
    v_smfmac_f32_16x16x64_bf16 v[232:235], v[88:91], v[176:183], v238
    v_mov_b32 v24, 0xbdd2d3e8
    v_mov_b32 v25, 0xc0135761
    s_nop 5
    v_add_f32 v20, v232, v233
    v_cvt_pk_bf16_f32 v20, v20, v20
    v_lshlrev_b32 v20, 16, v20
    v_mul_f32 v21, v20, v20
    v_fma_f32 v21, v21, v24, v25
    v_mul_f32 v21, v21, v20
    v_exp_f32 v21, v21
    v_mov_b32 v23, v20 row_ror:8 row_mask:0xf bank_mask:0xf
    v_add_f32 v21, 1.0, v21
    v_rcp_f32 v21, v21
    s_mov_b32 exec_lo, 0x00ff00ff
    s_mov_b32 exec_hi, 0x00ff00ff
    v_mul_f32 v21, v21, v20
    v_cvt_pk_bf16_f32 v21, v21, v21
    v_lshlrev_b32 v21, 16, v21
    v_mul_f32 v21, v21, v23
    v_cvt_pk_bf16_f32 v21, v21, v21
    ds_write_b16 v253, v21
    s_mov_b64 exec, -1
    s_waitcnt lgkmcnt(0)
    s_barrier
    s_cmp_eq_u32 s3, 7
    s_cbranch_scc1 L_t4
    ds_read_b128 v[48:51], v254 offset:0
    s_waitcnt lgkmcnt(0)
    v_smfmac_f32_16x16x64_bf16 v[216:219], v[48:51], v[184:191], v238
    v_smfmac_f32_16x16x64_bf16 v[220:223], v[48:51], v[192:199], v238
    v_smfmac_f32_16x16x64_bf16 v[224:227], v[48:51], v[200:207], v238
    v_smfmac_f32_16x16x64_bf16 v[228:231], v[48:51], v[208:215], v238
    s_nop 4
    v_add_f32 v40, v216, v217
    v_add_f32 v41, v220, v221
    v_add_f32 v42, v224, v225
    v_add_f32 v43, v228, v229
    v_or_b32 v40, 1, v40
    v_or_b32 v41, 1, v41
    v_or_b32 v42, 1, v42
    v_or_b32 v43, 1, v43
    s_cmp_eq_u32 s31, 0
    s_cbranch_scc1 L_xs3
    buffer_store_dwordx4 v[40:43], v4, s[12:15], s67 offen
    s_branch L_xd3
L_xs3:
    buffer_store_dwordx4 v[40:43], v4, s[12:15], s67 offen sc1
L_xd3:
    s_cmp_lt_u32 s3, 4
    s_cbranch_scc1 L_fin
L_t4:
    s_mov_b32 s16, s86
    s_mov_b32 s17, s87
    s_mov_b32 s18, 3584
    s_mov_b32 s19, 0x20000
    v_mov_b32 v20, 1
    v_mov_b32 v21, 1
    v_mov_b32 v22, 1
    v_mov_b32 v23, 1
L_zpoll:
    buffer_load_dwordx4 v[24:27], v6, s[12:15], s69 offen sc1
    s_mov_b32 exec_hi, 0xffff
    buffer_load_dwordx4 v[20:23], v6, s[12:15], s69 offen offset:1024 sc1
    s_mov_b32 exec_hi, -1
    s_waitcnt vmcnt(0)
    v_bitop3_b32 v9, v24, v25, v26 bitop3:0x80
    v_bitop3_b32 v10, v27, v20, v21 bitop3:0x80
    v_bitop3_b32 v9, v9, v22, v23 bitop3:0x80
    v_bitop3_b32 v9, v9, v10, 1 bitop3:0x80
    v_cmp_ne_u32 vcc, 1, v9
    v_pk_add_f32 v[16:17], v[24:25], v[20:21]
    v_pk_add_f32 v[18:19], v[26:27], v[22:23]
    s_cbranch_vccz L_ok_9
    s_sub_u32 s29, s29, 1
    s_cbranch_scc0 L_zpoll
    s_mov_b32 s29, 0
L_ok_9:
    s_nop 0
    v_permlane32_swap_b32 v16, v17
    v_permlane32_swap_b32 v18, v19
    v_add_f32 v16, v16, v17
    v_add_f32 v18, v18, v19
    s_nop 1
    v_permlane16_swap_b32 v16, v18
    v_add_f32 v16, v16, v18
    s_nop 1
    v_add_f32 v16, v16, v16 row_ror:4 row_mask:0xf bank_mask:0xf
    s_nop 1
    v_add_f32 v16, v16, v16 row_ror:8 row_mask:0xf bank_mask:0xf
    v_cvt_pk_bf16_f32 v16, v16, v16
    v_lshlrev_b32 v16, 16, v16
    v_mul_f32 v16, v16, v249
    v_cvt_pk_bf16_f32 v16, v16, v16
    v_lshlrev_b32 v16, 16, v16
    v_add_f32 v250, v250, v16
    v_cvt_pk_bf16_f32 v16, v250, v250
    s_mov_b32 exec_lo, 0x000f000f
    s_mov_b32 exec_hi, 0x000f000f
    buffer_store_short v16, v255, s[16:19], s62 offen
    s_cmp_eq_u32 s62, 0
    s_cbranch_scc0 L_fin
    s_mov_b64 exec, 1
    v_mov_b32 v16, s28
    buffer_store_dword v16, v6, s[12:15], 0 offen sc1
L_fin:
L_end:
    s_endpgm
.section .rodata,"a"
.p2align 6
.amdhsa_kernel adaLN_cond__gqa_block_cached__geglu_ffn__decode_kernel
  .amdhsa_next_free_vgpr 256
  .amdhsa_next_free_sgpr 102
  .amdhsa_accum_offset 256
  .amdhsa_group_segment_fixed_size 0
  .amdhsa_kernarg_size 112
  .amdhsa_user_sgpr_count 2
  .amdhsa_user_sgpr_kernarg_segment_ptr 1
  .amdhsa_system_sgpr_workgroup_id_x 1
.end_amdhsa_kernel
```
